```python
import torch

def _softmax(x, axis=-1):
    return torch.softmax(x, dim=axis)
def _gelu(x):
    return torch.nn.functional.gelu(x, approximate="tanh")
def _silu(x):
    return torch.nn.functional.silu(x)
def _sigmoid(x):
    return torch.sigmoid(x)
def _layernorm(x, axis=-1, eps=1e-5):
    m = x.mean(dim=axis, keepdim=True)
    v = x.var(dim=axis, keepdim=True, unbiased=False)
    return (x - m) / torch.sqrt(v + eps)
def _scatter_add(tgt, idx, src, axis=0):
    return tgt.clone().index_add_(axis, idx, src)
def _segment_sum(src, seg, n):
    out = torch.zeros((n,) + src.shape[1:], dtype=src.dtype)
    return out.index_add_(0, seg, src)
def _pad(x, pw):
    flat = tuple(v for pair in reversed(pw) for v in pair)
    return torch.nn.functional.pad(x, flat)

kernel_name = 'standalone__low_rank_proj_linformer__sampling'

def setup_inputs():

    _w = (lambda a: (lambda t: t.to(torch.bfloat16) if t.is_floating_point() else t)(torch.as_tensor(a)))
    B, H, Sq, Skv, Dh, R = 8, 32, 16, 4096, 192, 8
    return {
        "q": _w((lambda *s: torch.randn(*s, dtype=torch.bfloat16) * 0.8)(B, H, Sq, Dh)),
        "k": _w((lambda *s: torch.randn(*s, dtype=torch.bfloat16) * 0.8)(B, H, Skv, Dh)),
        "v": _w((lambda *s: torch.randn(*s, dtype=torch.bfloat16) * 0.05)(B, H, Skv, Dh)),
        "e_proj": _w((lambda *s: torch.randn(*s, dtype=torch.bfloat16) * 0.8)(R, Skv) * (Skv ** -0.5)),
        "f_proj": _w((lambda *s: torch.randn(*s, dtype=torch.bfloat16) * 0.05)(R, Skv) * (Skv ** -0.5)),
    }

def reference(q, k, v, e_proj, f_proj):
    B, H, Sq, Dh = q.shape
    kp = torch.einsum("rn,bhnd->bhrd", e_proj, k)
    vp = torch.einsum("rn,bhnd->bhrd", f_proj, v)
    scores = torch.einsum("bhqd,bhrd->bhqr", q, kp) * (Dh ** -0.5)
    p = _softmax(scores, axis=-1)
    o = torch.einsum("bhqr,bhrd->bhqd", p, vp)
    return o
```

```asm
; @launch grid=(256,1,1) block=(256,1,1) lds=112384
.amdgcn_target "amdgcn-amd-amdhsa--gfx950"
.text
.globl standalone__low_rank_proj_linformer__sampling_kernel
.p2align 8
.type standalone__low_rank_proj_linformer__sampling_kernel,@function
standalone__low_rank_proj_linformer__sampling_kernel:
  s_cmp_ge_u32 s2, 256
  s_cbranch_scc1 L_done
  s_load_dwordx8 s[88:95], s[0:1], 0
  s_load_dwordx4 s[96:99], s[0:1], 32
  s_and_b32 s3, s2, 7
  s_lshr_b32 s72, s2, 3
  s_lshl_b32 s3, s3, 5
  s_or_b32 s72, s72, s3
  v_and_b32 v218, 63, v0
  v_lshrrev_b32 v224, 6, v0
  v_lshrrev_b32 v219, 4, v218
  v_readfirstlane_b32 s46, v224
  v_and_b32 v220, 15, v218
  v_mul_u32_u24 v212, 6144, v219
  v_lshl_add_u32 v212, v220, 4, v212
  v_cmp_gt_u32 vcc, 8, v220
  v_mov_b32 v224, 2944
  v_mov_b32 v225, 256
  v_add_u32 v214, 3200, v212
  v_cndmask_b32 v213, v224, v225, vcc
  v_add_u32 v213, v213, v212
  v_and_b32 v224, 7, v220
  v_lshlrev_b32 v215, 13, v224
  v_lshl_add_u32 v215, v219, 5, v215
  v_lshrrev_b32 v224, 3, v220
  v_lshl_add_u32 v215, v224, 4, v215
  v_mov_b32 v221, 0
  v_mov_b32 v223, 1
  s_mul_i32 s55, s72, 0x180000
  s_mul_i32 s47, s72, 13
  s_add_u32 s47, s47, s46
  s_and_b32 s57, s47, 63
  s_mul_i32 s50, s57, 24576
  s_lshl_b32 s51, s57, 7
  s_mov_b32 s34, 0x180000
  s_mov_b32 s35, 0x00020000
  s_mov_b32 s42, 0x180000
  s_mov_b32 s43, 0x00020000
  s_mov_b32 s38, 65536
  s_mov_b32 s39, 0x00020000
  s_waitcnt lgkmcnt(0)
  s_add_u32 s32, s90, s55
  s_addc_u32 s33, s91, 0
  s_mov_b32 s36, s94
  s_mov_b32 s37, s95
  buffer_load_dwordx4 v[0:3], v212, s[32:35], s50 offen offset:0 nt
  buffer_load_dwordx4 v[4:7], v212, s[32:35], s50 offen offset:384 nt
  buffer_load_dwordx4 v[8:11], v212, s[32:35], s50 offen offset:768 nt
  buffer_load_dwordx4 v[12:15], v212, s[32:35], s50 offen offset:1152 nt
  buffer_load_dwordx4 v[16:19], v212, s[32:35], s50 offen offset:1536 nt
  buffer_load_dwordx4 v[20:23], v212, s[32:35], s50 offen offset:1920 nt
  buffer_load_dwordx4 v[24:27], v212, s[32:35], s50 offen offset:2304 nt
  buffer_load_dwordx4 v[28:31], v212, s[32:35], s50 offen offset:2688 nt
  buffer_load_dwordx4 a[96:99], v215, s[36:39], s51 offen
  buffer_load_dwordx4 v[32:35], v213, s[32:35], s50 offen offset:0 nt
  buffer_load_dwordx4 v[36:39], v213, s[32:35], s50 offen offset:384 nt
  buffer_load_dwordx4 v[40:43], v213, s[32:35], s50 offen offset:768 nt
  buffer_load_dwordx4 v[44:47], v213, s[32:35], s50 offen offset:1152 nt
  buffer_load_dwordx4 v[48:51], v213, s[32:35], s50 offen offset:1536 nt
  buffer_load_dwordx4 v[52:55], v213, s[32:35], s50 offen offset:1920 nt
  buffer_load_dwordx4 v[56:59], v213, s[32:35], s50 offen offset:2304 nt
  buffer_load_dwordx4 v[60:63], v213, s[32:35], s50 offen offset:2688 nt
  buffer_load_dwordx4 v[64:67], v214, s[32:35], s50 offen offset:0 nt
  buffer_load_dwordx4 v[68:71], v214, s[32:35], s50 offen offset:384 nt
  buffer_load_dwordx4 v[72:75], v214, s[32:35], s50 offen offset:768 nt
  buffer_load_dwordx4 v[76:79], v214, s[32:35], s50 offen offset:1152 nt
  buffer_load_dwordx4 v[80:83], v214, s[32:35], s50 offen offset:1536 nt
  buffer_load_dwordx4 v[84:87], v214, s[32:35], s50 offen offset:1920 nt
  buffer_load_dwordx4 v[88:91], v214, s[32:35], s50 offen offset:2304 nt
  buffer_load_dwordx4 v[92:95], v214, s[32:35], s50 offen offset:2688 nt
  s_mov_b32 s40, s32
  s_mov_b32 s41, s33
  s_add_u32 s56, s47, 4
  s_and_b32 s57, s56, 63
  s_mul_i32 s58, s57, 24576
  s_lshl_b32 s51, s57, 7
  buffer_load_dwordx4 v[96:99], v212, s[40:43], s58 offen offset:0 nt
  buffer_load_dwordx4 v[100:103], v212, s[40:43], s58 offen offset:384 nt
  buffer_load_dwordx4 v[104:107], v212, s[40:43], s58 offen offset:768 nt
  buffer_load_dwordx4 v[108:111], v212, s[40:43], s58 offen offset:1152 nt
  buffer_load_dwordx4 v[112:115], v212, s[40:43], s58 offen offset:1536 nt
  buffer_load_dwordx4 v[116:119], v212, s[40:43], s58 offen offset:1920 nt
  buffer_load_dwordx4 v[120:123], v212, s[40:43], s58 offen offset:2304 nt
  buffer_load_dwordx4 v[124:127], v212, s[40:43], s58 offen offset:2688 nt
  buffer_load_dwordx4 a[104:107], v215, s[36:39], s51 offen
  buffer_load_dwordx4 v[128:131], v213, s[40:43], s58 offen offset:0 nt
  buffer_load_dwordx4 v[132:135], v213, s[40:43], s58 offen offset:384 nt
  buffer_load_dwordx4 v[136:139], v213, s[40:43], s58 offen offset:768 nt
  buffer_load_dwordx4 v[140:143], v213, s[40:43], s58 offen offset:1152 nt
  buffer_load_dwordx4 v[144:147], v213, s[40:43], s58 offen offset:1536 nt
  buffer_load_dwordx4 v[148:151], v213, s[40:43], s58 offen offset:1920 nt
  buffer_load_dwordx4 v[152:155], v213, s[40:43], s58 offen offset:2304 nt
  buffer_load_dwordx4 v[156:159], v213, s[40:43], s58 offen offset:2688 nt
  buffer_load_dwordx4 v[160:163], v214, s[40:43], s58 offen offset:0 nt
  buffer_load_dwordx4 v[164:167], v214, s[40:43], s58 offen offset:384 nt
  buffer_load_dwordx4 v[168:171], v214, s[40:43], s58 offen offset:768 nt
  buffer_load_dwordx4 v[172:175], v214, s[40:43], s58 offen offset:1152 nt
  buffer_load_dwordx4 v[176:179], v214, s[40:43], s58 offen offset:1536 nt
  buffer_load_dwordx4 v[180:183], v214, s[40:43], s58 offen offset:1920 nt
  buffer_load_dwordx4 v[184:187], v214, s[40:43], s58 offen offset:2304 nt
  buffer_load_dwordx4 v[188:191], v214, s[40:43], s58 offen offset:2688 nt
  s_mov_b32 s49, 2
  s_mul_i32 s56, s72, 6144
  s_add_u32 s8, s90, s55
  s_addc_u32 s9, s91, 0
  s_mov_b32 s10, 1572864
  s_mov_b32 s11, 0x00020000
  s_add_u32 s12, s92, s55
  s_addc_u32 s13, s93, 0
  s_mov_b32 s14, 1572864
  s_mov_b32 s15, 0x00020000
  s_mov_b32 s16, s94
  s_mov_b32 s17, s95
  s_mov_b32 s18, 65536
  s_mov_b32 s19, 0x00020000
  s_mov_b32 s20, s96
  s_mov_b32 s21, s97
  s_mov_b32 s22, 65536
  s_mov_b32 s23, 0x00020000
  s_add_u32 s24, s88, s56
  s_addc_u32 s25, s89, 0
  s_mov_b32 s26, 6144
  s_mov_b32 s27, 0x00020000
  s_add_u32 s28, s98, s56
  s_addc_u32 s29, s99, 0
  s_mov_b32 s30, 6144
  s_mov_b32 s31, 0x00020000
  s_mov_b32 s52, 0x05040100
  s_mov_b32 s53, 0x07060302
  v_mov_b32 v228, 0
  ds_write_b32 v221, v228 offset:3200
  v_accvgpr_write_b32 a0, 0
  v_accvgpr_write_b32 a1, 0
  v_accvgpr_write_b32 a2, 0
  v_accvgpr_write_b32 a3, 0
  v_accvgpr_write_b32 a4, 0
  v_accvgpr_write_b32 a5, 0
  v_accvgpr_write_b32 a6, 0
  v_accvgpr_write_b32 a7, 0
  v_accvgpr_write_b32 a8, 0
  v_accvgpr_write_b32 a9, 0
  v_accvgpr_write_b32 a10, 0
  v_accvgpr_write_b32 a11, 0
  v_accvgpr_write_b32 a12, 0
  v_accvgpr_write_b32 a13, 0
  v_accvgpr_write_b32 a14, 0
  v_accvgpr_write_b32 a15, 0
  v_accvgpr_write_b32 a16, 0
  v_accvgpr_write_b32 a17, 0
  v_accvgpr_write_b32 a18, 0
  v_accvgpr_write_b32 a19, 0
  v_accvgpr_write_b32 a20, 0
  v_accvgpr_write_b32 a21, 0
  v_accvgpr_write_b32 a22, 0
  v_accvgpr_write_b32 a23, 0
  v_accvgpr_write_b32 a24, 0
  v_accvgpr_write_b32 a25, 0
  v_accvgpr_write_b32 a26, 0
  v_accvgpr_write_b32 a27, 0
  v_accvgpr_write_b32 a28, 0
  v_accvgpr_write_b32 a29, 0
  v_accvgpr_write_b32 a30, 0
  v_accvgpr_write_b32 a31, 0
  v_accvgpr_write_b32 a32, 0
  v_accvgpr_write_b32 a33, 0
  v_accvgpr_write_b32 a34, 0
  v_accvgpr_write_b32 a35, 0
  v_accvgpr_write_b32 a36, 0
  v_accvgpr_write_b32 a37, 0
  v_accvgpr_write_b32 a38, 0
  v_accvgpr_write_b32 a39, 0
  v_accvgpr_write_b32 a40, 0
  v_accvgpr_write_b32 a41, 0
  v_accvgpr_write_b32 a42, 0
  v_accvgpr_write_b32 a43, 0
  v_accvgpr_write_b32 a44, 0
  v_accvgpr_write_b32 a45, 0
  v_accvgpr_write_b32 a46, 0
  v_accvgpr_write_b32 a47, 0
  v_accvgpr_write_b32 a48, 0
  v_accvgpr_write_b32 a49, 0
  v_accvgpr_write_b32 a50, 0
  v_accvgpr_write_b32 a51, 0
  v_accvgpr_write_b32 a52, 0
  v_accvgpr_write_b32 a53, 0
  v_accvgpr_write_b32 a54, 0
  v_accvgpr_write_b32 a55, 0
  v_accvgpr_write_b32 a56, 0
  v_accvgpr_write_b32 a57, 0
  v_accvgpr_write_b32 a58, 0
  v_accvgpr_write_b32 a59, 0
  v_accvgpr_write_b32 a60, 0
  v_accvgpr_write_b32 a61, 0
  v_accvgpr_write_b32 a62, 0
  v_accvgpr_write_b32 a63, 0
  v_accvgpr_write_b32 a64, 0
  v_accvgpr_write_b32 a65, 0
  v_accvgpr_write_b32 a66, 0
  v_accvgpr_write_b32 a67, 0
  v_accvgpr_write_b32 a68, 0
  v_accvgpr_write_b32 a69, 0
  v_accvgpr_write_b32 a70, 0
  v_accvgpr_write_b32 a71, 0
  v_accvgpr_write_b32 a72, 0
  v_accvgpr_write_b32 a73, 0
  v_accvgpr_write_b32 a74, 0
  v_accvgpr_write_b32 a75, 0
  v_accvgpr_write_b32 a76, 0
  v_accvgpr_write_b32 a77, 0
  v_accvgpr_write_b32 a78, 0
  v_accvgpr_write_b32 a79, 0
  v_accvgpr_write_b32 a80, 0
  v_accvgpr_write_b32 a81, 0
  v_accvgpr_write_b32 a82, 0
  v_accvgpr_write_b32 a83, 0
  v_accvgpr_write_b32 a84, 0
  v_accvgpr_write_b32 a85, 0
  v_accvgpr_write_b32 a86, 0
  v_accvgpr_write_b32 a87, 0
  v_accvgpr_write_b32 a88, 0
  v_accvgpr_write_b32 a89, 0
  v_accvgpr_write_b32 a90, 0
  v_accvgpr_write_b32 a91, 0
  v_accvgpr_write_b32 a92, 0
  v_accvgpr_write_b32 a93, 0
  v_accvgpr_write_b32 a94, 0
  v_accvgpr_write_b32 a95, 0
  s_waitcnt lgkmcnt(0)
  s_barrier
  s_mov_b32 s54, 0
L_kloop:
  s_barrier
  s_waitcnt vmcnt(41)
  s_cmp_lg_u32 s54, 1
  s_cbranch_scc1 L_noside1
  s_cmp_lg_u32 s46, 1
  s_cbranch_scc1 L_noside1
  v_lshlrev_b32 v224, 4, v218
  s_mov_b32 m0, 3840
  s_mov_b32 s55, 4096
  buffer_load_dwordx4 v224, s[24:27], 0 offen offset:0 nt lds
  buffer_load_dwordx4 v224, s[24:27], 0 offen offset:1024 nt lds
  buffer_load_dwordx4 v224, s[24:27], 0 offen offset:2048 nt lds
  buffer_load_dwordx4 v224, s[24:27], 0 offen offset:3072 nt lds
  s_mov_b32 m0, 7936
  s_nop 0
  buffer_load_dwordx4 v224, s[24:27], s55 offen offset:0 nt lds
  buffer_load_dwordx4 v224, s[24:27], s55 offen offset:1024 nt lds
L_noside1:
  v_perm_b32 v192, v4, v0, s52
  v_perm_b32 v193, v12, v8, s52
  v_perm_b32 v194, v20, v16, s52
  v_perm_b32 v195, v28, v24, s52
  v_perm_b32 v196, v4, v0, s53
  v_perm_b32 v197, v12, v8, s53
  v_perm_b32 v198, v20, v16, s53
  v_perm_b32 v199, v28, v24, s53
  v_mfma_f32_16x16x32_bf16 a[0:3], a[96:99], v[192:195], a[0:3]
  v_perm_b32 v200, v5, v1, s52
  v_perm_b32 v201, v13, v9, s52
  v_perm_b32 v202, v21, v17, s52
  v_perm_b32 v203, v29, v25, s52
  v_mfma_f32_16x16x32_bf16 a[4:7], a[96:99], v[196:199], a[4:7]
  v_perm_b32 v192, v5, v1, s53
  v_perm_b32 v193, v13, v9, s53
  v_perm_b32 v194, v21, v17, s53
  v_perm_b32 v195, v29, v25, s53
  v_mfma_f32_16x16x32_bf16 a[8:11], a[96:99], v[200:203], a[8:11]
  v_perm_b32 v196, v6, v2, s52
  v_perm_b32 v197, v14, v10, s52
  v_perm_b32 v198, v22, v18, s52
  v_perm_b32 v199, v30, v26, s52
  v_mfma_f32_16x16x32_bf16 a[12:15], a[96:99], v[192:195], a[12:15]
  v_perm_b32 v200, v6, v2, s53
  v_perm_b32 v201, v14, v10, s53
  v_perm_b32 v202, v22, v18, s53
  v_perm_b32 v203, v30, v26, s53
  v_mfma_f32_16x16x32_bf16 a[16:19], a[96:99], v[196:199], a[16:19]
  v_perm_b32 v192, v7, v3, s52
  v_perm_b32 v193, v15, v11, s52
  v_perm_b32 v194, v23, v19, s52
  v_perm_b32 v195, v31, v27, s52
  v_mfma_f32_16x16x32_bf16 a[20:23], a[96:99], v[200:203], a[20:23]
  v_perm_b32 v196, v7, v3, s53
  v_perm_b32 v197, v15, v11, s53
  v_perm_b32 v198, v23, v19, s53
  v_perm_b32 v199, v31, v27, s53
  v_mfma_f32_16x16x32_bf16 a[24:27], a[96:99], v[192:195], a[24:27]
  s_nop 1
  v_mfma_f32_16x16x32_bf16 a[28:31], a[96:99], v[196:199], a[28:31]
  s_cmp_ge_u32 s49, 16
  s_cselect_b32 s32, s12, s8
  s_cselect_b32 s33, s13, s9
  s_cselect_b32 s36, s20, s16
  s_cselect_b32 s37, s21, s17
  s_lshl_b32 s55, s49, 2
  s_add_u32 s55, s55, s47
  s_and_b32 s55, s55, 63
  s_mul_i32 s50, s55, 24576
  s_lshl_b32 s51, s55, 7
  s_add_u32 s49, s49, 1
  buffer_load_dwordx4 v[0:3], v212, s[32:35], s50 offen offset:0 nt
  buffer_load_dwordx4 v[4:7], v212, s[32:35], s50 offen offset:384 nt
  buffer_load_dwordx4 v[8:11], v212, s[32:35], s50 offen offset:768 nt
  buffer_load_dwordx4 v[12:15], v212, s[32:35], s50 offen offset:1152 nt
  buffer_load_dwordx4 v[16:19], v212, s[32:35], s50 offen offset:1536 nt
  buffer_load_dwordx4 v[20:23], v212, s[32:35], s50 offen offset:1920 nt
  buffer_load_dwordx4 v[24:27], v212, s[32:35], s50 offen offset:2304 nt
  buffer_load_dwordx4 v[28:31], v212, s[32:35], s50 offen offset:2688 nt
  buffer_load_dwordx4 a[100:103], v215, s[36:39], s51 offen
  s_waitcnt vmcnt(42)
  v_perm_b32 v192, v36, v32, s52
  v_perm_b32 v193, v44, v40, s52
  v_perm_b32 v194, v52, v48, s52
  v_perm_b32 v195, v60, v56, s52
  v_perm_b32 v196, v36, v32, s53
  v_perm_b32 v197, v44, v40, s53
  v_perm_b32 v198, v52, v48, s53
  v_perm_b32 v199, v60, v56, s53
  v_mfma_f32_16x16x32_bf16 a[32:35], a[96:99], v[192:195], a[32:35]
  v_perm_b32 v200, v37, v33, s52
  v_perm_b32 v201, v45, v41, s52
  v_perm_b32 v202, v53, v49, s52
  v_perm_b32 v203, v61, v57, s52
  v_mfma_f32_16x16x32_bf16 a[36:39], a[96:99], v[196:199], a[36:39]
  v_perm_b32 v192, v37, v33, s53
  v_perm_b32 v193, v45, v41, s53
  v_perm_b32 v194, v53, v49, s53
  v_perm_b32 v195, v61, v57, s53
  v_mfma_f32_16x16x32_bf16 a[40:43], a[96:99], v[200:203], a[40:43]
  v_perm_b32 v196, v38, v34, s52
  v_perm_b32 v197, v46, v42, s52
  v_perm_b32 v198, v54, v50, s52
  v_perm_b32 v199, v62, v58, s52
  v_mfma_f32_16x16x32_bf16 a[44:47], a[96:99], v[192:195], a[44:47]
  v_perm_b32 v200, v38, v34, s53
  v_perm_b32 v201, v46, v42, s53
  v_perm_b32 v202, v54, v50, s53
  v_perm_b32 v203, v62, v58, s53
  v_mfma_f32_16x16x32_bf16 a[48:51], a[96:99], v[196:199], a[48:51]
  v_perm_b32 v192, v39, v35, s52
  v_perm_b32 v193, v47, v43, s52
  v_perm_b32 v194, v55, v51, s52
  v_perm_b32 v195, v63, v59, s52
  v_mfma_f32_16x16x32_bf16 a[52:55], a[96:99], v[200:203], a[52:55]
  v_perm_b32 v196, v39, v35, s53
  v_perm_b32 v197, v47, v43, s53
  v_perm_b32 v198, v55, v51, s53
  v_perm_b32 v199, v63, v59, s53
  v_mfma_f32_16x16x32_bf16 a[56:59], a[96:99], v[192:195], a[56:59]
  s_nop 1
  v_mfma_f32_16x16x32_bf16 a[60:63], a[96:99], v[196:199], a[60:63]
  buffer_load_dwordx4 v[32:35], v213, s[32:35], s50 offen offset:0 nt
  buffer_load_dwordx4 v[36:39], v213, s[32:35], s50 offen offset:384 nt
  buffer_load_dwordx4 v[40:43], v213, s[32:35], s50 offen offset:768 nt
  buffer_load_dwordx4 v[44:47], v213, s[32:35], s50 offen offset:1152 nt
  buffer_load_dwordx4 v[48:51], v213, s[32:35], s50 offen offset:1536 nt
  buffer_load_dwordx4 v[52:55], v213, s[32:35], s50 offen offset:1920 nt
  buffer_load_dwordx4 v[56:59], v213, s[32:35], s50 offen offset:2304 nt
  buffer_load_dwordx4 v[60:63], v213, s[32:35], s50 offen offset:2688 nt
  s_waitcnt vmcnt(42)
  v_perm_b32 v192, v68, v64, s52
  v_perm_b32 v193, v76, v72, s52
  v_perm_b32 v194, v84, v80, s52
  v_perm_b32 v195, v92, v88, s52
  v_perm_b32 v196, v68, v64, s53
  v_perm_b32 v197, v76, v72, s53
  v_perm_b32 v198, v84, v80, s53
  v_perm_b32 v199, v92, v88, s53
  v_mfma_f32_16x16x32_bf16 a[64:67], a[96:99], v[192:195], a[64:67]
  v_perm_b32 v200, v69, v65, s52
  v_perm_b32 v201, v77, v73, s52
  v_perm_b32 v202, v85, v81, s52
  v_perm_b32 v203, v93, v89, s52
  v_mfma_f32_16x16x32_bf16 a[68:71], a[96:99], v[196:199], a[68:71]
  v_perm_b32 v192, v69, v65, s53
  v_perm_b32 v193, v77, v73, s53
  v_perm_b32 v194, v85, v81, s53
  v_perm_b32 v195, v93, v89, s53
  v_mfma_f32_16x16x32_bf16 a[72:75], a[96:99], v[200:203], a[72:75]
  v_perm_b32 v196, v70, v66, s52
  v_perm_b32 v197, v78, v74, s52
  v_perm_b32 v198, v86, v82, s52
  v_perm_b32 v199, v94, v90, s52
  v_mfma_f32_16x16x32_bf16 a[76:79], a[96:99], v[192:195], a[76:79]
  v_perm_b32 v200, v70, v66, s53
  v_perm_b32 v201, v78, v74, s53
  v_perm_b32 v202, v86, v82, s53
  v_perm_b32 v203, v94, v90, s53
  v_mfma_f32_16x16x32_bf16 a[80:83], a[96:99], v[196:199], a[80:83]
  v_perm_b32 v192, v71, v67, s52
  v_perm_b32 v193, v79, v75, s52
  v_perm_b32 v194, v87, v83, s52
  v_perm_b32 v195, v95, v91, s52
  v_mfma_f32_16x16x32_bf16 a[84:87], a[96:99], v[200:203], a[84:87]
  v_perm_b32 v196, v71, v67, s53
  v_perm_b32 v197, v79, v75, s53
  v_perm_b32 v198, v87, v83, s53
  v_perm_b32 v199, v95, v91, s53
  v_mfma_f32_16x16x32_bf16 a[88:91], a[96:99], v[192:195], a[88:91]
  s_nop 1
  v_mfma_f32_16x16x32_bf16 a[92:95], a[96:99], v[196:199], a[92:95]
  buffer_load_dwordx4 v[64:67], v214, s[32:35], s50 offen offset:0 nt
  buffer_load_dwordx4 v[68:71], v214, s[32:35], s50 offen offset:384 nt
  buffer_load_dwordx4 v[72:75], v214, s[32:35], s50 offen offset:768 nt
  buffer_load_dwordx4 v[76:79], v214, s[32:35], s50 offen offset:1152 nt
  buffer_load_dwordx4 v[80:83], v214, s[32:35], s50 offen offset:1536 nt
  buffer_load_dwordx4 v[84:87], v214, s[32:35], s50 offen offset:1920 nt
  buffer_load_dwordx4 v[88:91], v214, s[32:35], s50 offen offset:2304 nt
  buffer_load_dwordx4 v[92:95], v214, s[32:35], s50 offen offset:2688 nt
  s_waitcnt vmcnt(41)
  v_perm_b32 v192, v100, v96, s52
  v_perm_b32 v193, v108, v104, s52
  v_perm_b32 v194, v116, v112, s52
  v_perm_b32 v195, v124, v120, s52
  v_perm_b32 v196, v100, v96, s53
  v_perm_b32 v197, v108, v104, s53
  v_perm_b32 v198, v116, v112, s53
  v_perm_b32 v199, v124, v120, s53
  v_mfma_f32_16x16x32_bf16 a[0:3], a[104:107], v[192:195], a[0:3]
  v_perm_b32 v200, v101, v97, s52
  v_perm_b32 v201, v109, v105, s52
  v_perm_b32 v202, v117, v113, s52
  v_perm_b32 v203, v125, v121, s52
  v_mfma_f32_16x16x32_bf16 a[4:7], a[104:107], v[196:199], a[4:7]
  v_perm_b32 v192, v101, v97, s53
  v_perm_b32 v193, v109, v105, s53
  v_perm_b32 v194, v117, v113, s53
  v_perm_b32 v195, v125, v121, s53
  v_mfma_f32_16x16x32_bf16 a[8:11], a[104:107], v[200:203], a[8:11]
  v_perm_b32 v196, v102, v98, s52
  v_perm_b32 v197, v110, v106, s52
  v_perm_b32 v198, v118, v114, s52
  v_perm_b32 v199, v126, v122, s52
  v_mfma_f32_16x16x32_bf16 a[12:15], a[104:107], v[192:195], a[12:15]
  v_perm_b32 v200, v102, v98, s53
  v_perm_b32 v201, v110, v106, s53
  v_perm_b32 v202, v118, v114, s53
  v_perm_b32 v203, v126, v122, s53
  v_mfma_f32_16x16x32_bf16 a[16:19], a[104:107], v[196:199], a[16:19]
  v_perm_b32 v192, v103, v99, s52
  v_perm_b32 v193, v111, v107, s52
  v_perm_b32 v194, v119, v115, s52
  v_perm_b32 v195, v127, v123, s52
  v_mfma_f32_16x16x32_bf16 a[20:23], a[104:107], v[200:203], a[20:23]
  v_perm_b32 v196, v103, v99, s53
  v_perm_b32 v197, v111, v107, s53
  v_perm_b32 v198, v119, v115, s53
  v_perm_b32 v199, v127, v123, s53
  v_mfma_f32_16x16x32_bf16 a[24:27], a[104:107], v[192:195], a[24:27]
  s_nop 1
  v_mfma_f32_16x16x32_bf16 a[28:31], a[104:107], v[196:199], a[28:31]
  s_cmp_ge_u32 s49, 16
  s_cselect_b32 s40, s12, s8
  s_cselect_b32 s41, s13, s9
  s_cselect_b32 s36, s20, s16
  s_cselect_b32 s37, s21, s17
  s_lshl_b32 s55, s49, 2
  s_add_u32 s55, s55, s47
  s_and_b32 s55, s55, 63
  s_mul_i32 s58, s55, 24576
  s_lshl_b32 s51, s55, 7
  s_add_u32 s49, s49, 1
  buffer_load_dwordx4 v[96:99], v212, s[40:43], s58 offen offset:0 nt
  buffer_load_dwordx4 v[100:103], v212, s[40:43], s58 offen offset:384 nt
  buffer_load_dwordx4 v[104:107], v212, s[40:43], s58 offen offset:768 nt
  buffer_load_dwordx4 v[108:111], v212, s[40:43], s58 offen offset:1152 nt
  buffer_load_dwordx4 v[112:115], v212, s[40:43], s58 offen offset:1536 nt
  buffer_load_dwordx4 v[116:119], v212, s[40:43], s58 offen offset:1920 nt
  buffer_load_dwordx4 v[120:123], v212, s[40:43], s58 offen offset:2304 nt
  buffer_load_dwordx4 v[124:127], v212, s[40:43], s58 offen offset:2688 nt
  buffer_load_dwordx4 a[108:111], v215, s[36:39], s51 offen
  s_waitcnt vmcnt(42)
  v_perm_b32 v192, v132, v128, s52
  v_perm_b32 v193, v140, v136, s52
  v_perm_b32 v194, v148, v144, s52
  v_perm_b32 v195, v156, v152, s52
  v_perm_b32 v196, v132, v128, s53
  v_perm_b32 v197, v140, v136, s53
  v_perm_b32 v198, v148, v144, s53
  v_perm_b32 v199, v156, v152, s53
  v_mfma_f32_16x16x32_bf16 a[32:35], a[104:107], v[192:195], a[32:35]
  v_perm_b32 v200, v133, v129, s52
  v_perm_b32 v201, v141, v137, s52
  v_perm_b32 v202, v149, v145, s52
  v_perm_b32 v203, v157, v153, s52
  v_mfma_f32_16x16x32_bf16 a[36:39], a[104:107], v[196:199], a[36:39]
  v_perm_b32 v192, v133, v129, s53
  v_perm_b32 v193, v141, v137, s53
  v_perm_b32 v194, v149, v145, s53
  v_perm_b32 v195, v157, v153, s53
  v_mfma_f32_16x16x32_bf16 a[40:43], a[104:107], v[200:203], a[40:43]
  v_perm_b32 v196, v134, v130, s52
  v_perm_b32 v197, v142, v138, s52
  v_perm_b32 v198, v150, v146, s52
  v_perm_b32 v199, v158, v154, s52
  v_mfma_f32_16x16x32_bf16 a[44:47], a[104:107], v[192:195], a[44:47]
  v_perm_b32 v200, v134, v130, s53
  v_perm_b32 v201, v142, v138, s53
  v_perm_b32 v202, v150, v146, s53
  v_perm_b32 v203, v158, v154, s53
  v_mfma_f32_16x16x32_bf16 a[48:51], a[104:107], v[196:199], a[48:51]
  v_perm_b32 v192, v135, v131, s52
  v_perm_b32 v193, v143, v139, s52
  v_perm_b32 v194, v151, v147, s52
  v_perm_b32 v195, v159, v155, s52
  v_mfma_f32_16x16x32_bf16 a[52:55], a[104:107], v[200:203], a[52:55]
  v_perm_b32 v196, v135, v131, s53
  v_perm_b32 v197, v143, v139, s53
  v_perm_b32 v198, v151, v147, s53
  v_perm_b32 v199, v159, v155, s53
  v_mfma_f32_16x16x32_bf16 a[56:59], a[104:107], v[192:195], a[56:59]
  s_nop 1
  v_mfma_f32_16x16x32_bf16 a[60:63], a[104:107], v[196:199], a[60:63]
  buffer_load_dwordx4 v[128:131], v213, s[40:43], s58 offen offset:0 nt
  buffer_load_dwordx4 v[132:135], v213, s[40:43], s58 offen offset:384 nt
  buffer_load_dwordx4 v[136:139], v213, s[40:43], s58 offen offset:768 nt
  buffer_load_dwordx4 v[140:143], v213, s[40:43], s58 offen offset:1152 nt
  buffer_load_dwordx4 v[144:147], v213, s[40:43], s58 offen offset:1536 nt
  buffer_load_dwordx4 v[148:151], v213, s[40:43], s58 offen offset:1920 nt
  buffer_load_dwordx4 v[152:155], v213, s[40:43], s58 offen offset:2304 nt
  buffer_load_dwordx4 v[156:159], v213, s[40:43], s58 offen offset:2688 nt
  s_waitcnt vmcnt(42)
  v_perm_b32 v192, v164, v160, s52
  v_perm_b32 v193, v172, v168, s52
  v_perm_b32 v194, v180, v176, s52
  v_perm_b32 v195, v188, v184, s52
  v_perm_b32 v196, v164, v160, s53
  v_perm_b32 v197, v172, v168, s53
  v_perm_b32 v198, v180, v176, s53
  v_perm_b32 v199, v188, v184, s53
  v_mfma_f32_16x16x32_bf16 a[64:67], a[104:107], v[192:195], a[64:67]
  v_perm_b32 v200, v165, v161, s52
  v_perm_b32 v201, v173, v169, s52
  v_perm_b32 v202, v181, v177, s52
  v_perm_b32 v203, v189, v185, s52
  v_mfma_f32_16x16x32_bf16 a[68:71], a[104:107], v[196:199], a[68:71]
  v_perm_b32 v192, v165, v161, s53
  v_perm_b32 v193, v173, v169, s53
  v_perm_b32 v194, v181, v177, s53
  v_perm_b32 v195, v189, v185, s53
  v_mfma_f32_16x16x32_bf16 a[72:75], a[104:107], v[200:203], a[72:75]
  v_perm_b32 v196, v166, v162, s52
  v_perm_b32 v197, v174, v170, s52
  v_perm_b32 v198, v182, v178, s52
  v_perm_b32 v199, v190, v186, s52
  v_mfma_f32_16x16x32_bf16 a[76:79], a[104:107], v[192:195], a[76:79]
  v_perm_b32 v200, v166, v162, s53
  v_perm_b32 v201, v174, v170, s53
  v_perm_b32 v202, v182, v178, s53
  v_perm_b32 v203, v190, v186, s53
  v_mfma_f32_16x16x32_bf16 a[80:83], a[104:107], v[196:199], a[80:83]
  v_perm_b32 v192, v167, v163, s52
  v_perm_b32 v193, v175, v171, s52
  v_perm_b32 v194, v183, v179, s52
  v_perm_b32 v195, v191, v187, s52
  v_mfma_f32_16x16x32_bf16 a[84:87], a[104:107], v[200:203], a[84:87]
  v_perm_b32 v196, v167, v163, s53
  v_perm_b32 v197, v175, v171, s53
  v_perm_b32 v198, v183, v179, s53
  v_perm_b32 v199, v191, v187, s53
  v_mfma_f32_16x16x32_bf16 a[88:91], a[104:107], v[192:195], a[88:91]
  s_nop 1
  v_mfma_f32_16x16x32_bf16 a[92:95], a[104:107], v[196:199], a[92:95]
  buffer_load_dwordx4 v[160:163], v214, s[40:43], s58 offen offset:0 nt
  buffer_load_dwordx4 v[164:167], v214, s[40:43], s58 offen offset:384 nt
  buffer_load_dwordx4 v[168:171], v214, s[40:43], s58 offen offset:768 nt
  buffer_load_dwordx4 v[172:175], v214, s[40:43], s58 offen offset:1152 nt
  buffer_load_dwordx4 v[176:179], v214, s[40:43], s58 offen offset:1536 nt
  buffer_load_dwordx4 v[180:183], v214, s[40:43], s58 offen offset:1920 nt
  buffer_load_dwordx4 v[184:187], v214, s[40:43], s58 offen offset:2304 nt
  buffer_load_dwordx4 v[188:191], v214, s[40:43], s58 offen offset:2688 nt
  s_waitcnt vmcnt(41)
  v_perm_b32 v192, v4, v0, s52
  v_perm_b32 v193, v12, v8, s52
  v_perm_b32 v194, v20, v16, s52
  v_perm_b32 v195, v28, v24, s52
  v_perm_b32 v196, v4, v0, s53
  v_perm_b32 v197, v12, v8, s53
  v_perm_b32 v198, v20, v16, s53
  v_perm_b32 v199, v28, v24, s53
  v_mfma_f32_16x16x32_bf16 a[0:3], a[100:103], v[192:195], a[0:3]
  v_perm_b32 v200, v5, v1, s52
  v_perm_b32 v201, v13, v9, s52
  v_perm_b32 v202, v21, v17, s52
  v_perm_b32 v203, v29, v25, s52
  v_mfma_f32_16x16x32_bf16 a[4:7], a[100:103], v[196:199], a[4:7]
  v_perm_b32 v192, v5, v1, s53
  v_perm_b32 v193, v13, v9, s53
  v_perm_b32 v194, v21, v17, s53
  v_perm_b32 v195, v29, v25, s53
  v_mfma_f32_16x16x32_bf16 a[8:11], a[100:103], v[200:203], a[8:11]
  v_perm_b32 v196, v6, v2, s52
  v_perm_b32 v197, v14, v10, s52
  v_perm_b32 v198, v22, v18, s52
  v_perm_b32 v199, v30, v26, s52
  v_mfma_f32_16x16x32_bf16 a[12:15], a[100:103], v[192:195], a[12:15]
  v_perm_b32 v200, v6, v2, s53
  v_perm_b32 v201, v14, v10, s53
  v_perm_b32 v202, v22, v18, s53
  v_perm_b32 v203, v30, v26, s53
  v_mfma_f32_16x16x32_bf16 a[16:19], a[100:103], v[196:199], a[16:19]
  v_perm_b32 v192, v7, v3, s52
  v_perm_b32 v193, v15, v11, s52
  v_perm_b32 v194, v23, v19, s52
  v_perm_b32 v195, v31, v27, s52
  v_mfma_f32_16x16x32_bf16 a[20:23], a[100:103], v[200:203], a[20:23]
  v_perm_b32 v196, v7, v3, s53
  v_perm_b32 v197, v15, v11, s53
  v_perm_b32 v198, v23, v19, s53
  v_perm_b32 v199, v31, v27, s53
  v_mfma_f32_16x16x32_bf16 a[24:27], a[100:103], v[192:195], a[24:27]
  s_nop 1
  v_mfma_f32_16x16x32_bf16 a[28:31], a[100:103], v[196:199], a[28:31]
  s_cmp_ge_u32 s49, 16
  s_cselect_b32 s32, s12, s8
  s_cselect_b32 s33, s13, s9
  s_cselect_b32 s36, s20, s16
  s_cselect_b32 s37, s21, s17
  s_lshl_b32 s55, s49, 2
  s_add_u32 s55, s55, s47
  s_and_b32 s55, s55, 63
  s_mul_i32 s50, s55, 24576
  s_lshl_b32 s51, s55, 7
  s_add_u32 s49, s49, 1
  buffer_load_dwordx4 v[0:3], v212, s[32:35], s50 offen offset:0 nt
  buffer_load_dwordx4 v[4:7], v212, s[32:35], s50 offen offset:384 nt
  buffer_load_dwordx4 v[8:11], v212, s[32:35], s50 offen offset:768 nt
  buffer_load_dwordx4 v[12:15], v212, s[32:35], s50 offen offset:1152 nt
  buffer_load_dwordx4 v[16:19], v212, s[32:35], s50 offen offset:1536 nt
  buffer_load_dwordx4 v[20:23], v212, s[32:35], s50 offen offset:1920 nt
  buffer_load_dwordx4 v[24:27], v212, s[32:35], s50 offen offset:2304 nt
  buffer_load_dwordx4 v[28:31], v212, s[32:35], s50 offen offset:2688 nt
  buffer_load_dwordx4 a[96:99], v215, s[36:39], s51 offen
  s_waitcnt vmcnt(42)
  v_perm_b32 v192, v36, v32, s52
  v_perm_b32 v193, v44, v40, s52
  v_perm_b32 v194, v52, v48, s52
  v_perm_b32 v195, v60, v56, s52
  v_perm_b32 v196, v36, v32, s53
  v_perm_b32 v197, v44, v40, s53
  v_perm_b32 v198, v52, v48, s53
  v_perm_b32 v199, v60, v56, s53
  v_mfma_f32_16x16x32_bf16 a[32:35], a[100:103], v[192:195], a[32:35]
  v_perm_b32 v200, v37, v33, s52
  v_perm_b32 v201, v45, v41, s52
  v_perm_b32 v202, v53, v49, s52
  v_perm_b32 v203, v61, v57, s52
  v_mfma_f32_16x16x32_bf16 a[36:39], a[100:103], v[196:199], a[36:39]
  v_perm_b32 v192, v37, v33, s53
  v_perm_b32 v193, v45, v41, s53
  v_perm_b32 v194, v53, v49, s53
  v_perm_b32 v195, v61, v57, s53
  v_mfma_f32_16x16x32_bf16 a[40:43], a[100:103], v[200:203], a[40:43]
  v_perm_b32 v196, v38, v34, s52
  v_perm_b32 v197, v46, v42, s52
  v_perm_b32 v198, v54, v50, s52
  v_perm_b32 v199, v62, v58, s52
  v_mfma_f32_16x16x32_bf16 a[44:47], a[100:103], v[192:195], a[44:47]
  v_perm_b32 v200, v38, v34, s53
  v_perm_b32 v201, v46, v42, s53
  v_perm_b32 v202, v54, v50, s53
  v_perm_b32 v203, v62, v58, s53
  v_mfma_f32_16x16x32_bf16 a[48:51], a[100:103], v[196:199], a[48:51]
  v_perm_b32 v192, v39, v35, s52
  v_perm_b32 v193, v47, v43, s52
  v_perm_b32 v194, v55, v51, s52
  v_perm_b32 v195, v63, v59, s52
  v_mfma_f32_16x16x32_bf16 a[52:55], a[100:103], v[200:203], a[52:55]
  v_perm_b32 v196, v39, v35, s53
  v_perm_b32 v197, v47, v43, s53
  v_perm_b32 v198, v55, v51, s53
  v_perm_b32 v199, v63, v59, s53
  v_mfma_f32_16x16x32_bf16 a[56:59], a[100:103], v[192:195], a[56:59]
  s_nop 1
  v_mfma_f32_16x16x32_bf16 a[60:63], a[100:103], v[196:199], a[60:63]
  buffer_load_dwordx4 v[32:35], v213, s[32:35], s50 offen offset:0 nt
  buffer_load_dwordx4 v[36:39], v213, s[32:35], s50 offen offset:384 nt
  buffer_load_dwordx4 v[40:43], v213, s[32:35], s50 offen offset:768 nt
  buffer_load_dwordx4 v[44:47], v213, s[32:35], s50 offen offset:1152 nt
  buffer_load_dwordx4 v[48:51], v213, s[32:35], s50 offen offset:1536 nt
  buffer_load_dwordx4 v[52:55], v213, s[32:35], s50 offen offset:1920 nt
  buffer_load_dwordx4 v[56:59], v213, s[32:35], s50 offen offset:2304 nt
  buffer_load_dwordx4 v[60:63], v213, s[32:35], s50 offen offset:2688 nt
  s_waitcnt vmcnt(42)
  v_perm_b32 v192, v68, v64, s52
  v_perm_b32 v193, v76, v72, s52
  v_perm_b32 v194, v84, v80, s52
  v_perm_b32 v195, v92, v88, s52
  v_perm_b32 v196, v68, v64, s53
  v_perm_b32 v197, v76, v72, s53
  v_perm_b32 v198, v84, v80, s53
  v_perm_b32 v199, v92, v88, s53
  v_mfma_f32_16x16x32_bf16 a[64:67], a[100:103], v[192:195], a[64:67]
  v_perm_b32 v200, v69, v65, s52
  v_perm_b32 v201, v77, v73, s52
  v_perm_b32 v202, v85, v81, s52
  v_perm_b32 v203, v93, v89, s52
  v_mfma_f32_16x16x32_bf16 a[68:71], a[100:103], v[196:199], a[68:71]
  v_perm_b32 v192, v69, v65, s53
  v_perm_b32 v193, v77, v73, s53
  v_perm_b32 v194, v85, v81, s53
  v_perm_b32 v195, v93, v89, s53
  v_mfma_f32_16x16x32_bf16 a[72:75], a[100:103], v[200:203], a[72:75]
  v_perm_b32 v196, v70, v66, s52
  v_perm_b32 v197, v78, v74, s52
  v_perm_b32 v198, v86, v82, s52
  v_perm_b32 v199, v94, v90, s52
  v_mfma_f32_16x16x32_bf16 a[76:79], a[100:103], v[192:195], a[76:79]
  v_perm_b32 v200, v70, v66, s53
  v_perm_b32 v201, v78, v74, s53
  v_perm_b32 v202, v86, v82, s53
  v_perm_b32 v203, v94, v90, s53
  v_mfma_f32_16x16x32_bf16 a[80:83], a[100:103], v[196:199], a[80:83]
  v_perm_b32 v192, v71, v67, s52
  v_perm_b32 v193, v79, v75, s52
  v_perm_b32 v194, v87, v83, s52
  v_perm_b32 v195, v95, v91, s52
  v_mfma_f32_16x16x32_bf16 a[84:87], a[100:103], v[200:203], a[84:87]
  v_perm_b32 v196, v71, v67, s53
  v_perm_b32 v197, v79, v75, s53
  v_perm_b32 v198, v87, v83, s53
  v_perm_b32 v199, v95, v91, s53
  v_mfma_f32_16x16x32_bf16 a[88:91], a[100:103], v[192:195], a[88:91]
  s_nop 1
  v_mfma_f32_16x16x32_bf16 a[92:95], a[100:103], v[196:199], a[92:95]
  buffer_load_dwordx4 v[64:67], v214, s[32:35], s50 offen offset:0 nt
  buffer_load_dwordx4 v[68:71], v214, s[32:35], s50 offen offset:384 nt
  buffer_load_dwordx4 v[72:75], v214, s[32:35], s50 offen offset:768 nt
  buffer_load_dwordx4 v[76:79], v214, s[32:35], s50 offen offset:1152 nt
  buffer_load_dwordx4 v[80:83], v214, s[32:35], s50 offen offset:1536 nt
  buffer_load_dwordx4 v[84:87], v214, s[32:35], s50 offen offset:1920 nt
  buffer_load_dwordx4 v[88:91], v214, s[32:35], s50 offen offset:2304 nt
  buffer_load_dwordx4 v[92:95], v214, s[32:35], s50 offen offset:2688 nt
  s_waitcnt vmcnt(41)
  v_perm_b32 v192, v100, v96, s52
  v_perm_b32 v193, v108, v104, s52
  v_perm_b32 v194, v116, v112, s52
  v_perm_b32 v195, v124, v120, s52
  v_perm_b32 v196, v100, v96, s53
  v_perm_b32 v197, v108, v104, s53
  v_perm_b32 v198, v116, v112, s53
  v_perm_b32 v199, v124, v120, s53
  v_mfma_f32_16x16x32_bf16 a[0:3], a[108:111], v[192:195], a[0:3]
  v_perm_b32 v200, v101, v97, s52
  v_perm_b32 v201, v109, v105, s52
  v_perm_b32 v202, v117, v113, s52
  v_perm_b32 v203, v125, v121, s52
  v_mfma_f32_16x16x32_bf16 a[4:7], a[108:111], v[196:199], a[4:7]
  v_perm_b32 v192, v101, v97, s53
  v_perm_b32 v193, v109, v105, s53
  v_perm_b32 v194, v117, v113, s53
  v_perm_b32 v195, v125, v121, s53
  v_mfma_f32_16x16x32_bf16 a[8:11], a[108:111], v[200:203], a[8:11]
  v_perm_b32 v196, v102, v98, s52
  v_perm_b32 v197, v110, v106, s52
  v_perm_b32 v198, v118, v114, s52
  v_perm_b32 v199, v126, v122, s52
  v_mfma_f32_16x16x32_bf16 a[12:15], a[108:111], v[192:195], a[12:15]
  v_perm_b32 v200, v102, v98, s53
  v_perm_b32 v201, v110, v106, s53
  v_perm_b32 v202, v118, v114, s53
  v_perm_b32 v203, v126, v122, s53
  v_mfma_f32_16x16x32_bf16 a[16:19], a[108:111], v[196:199], a[16:19]
  v_perm_b32 v192, v103, v99, s52
  v_perm_b32 v193, v111, v107, s52
  v_perm_b32 v194, v119, v115, s52
  v_perm_b32 v195, v127, v123, s52
  v_mfma_f32_16x16x32_bf16 a[20:23], a[108:111], v[200:203], a[20:23]
  v_perm_b32 v196, v103, v99, s53
  v_perm_b32 v197, v111, v107, s53
  v_perm_b32 v198, v119, v115, s53
  v_perm_b32 v199, v127, v123, s53
  v_mfma_f32_16x16x32_bf16 a[24:27], a[108:111], v[192:195], a[24:27]
  s_nop 1
  v_mfma_f32_16x16x32_bf16 a[28:31], a[108:111], v[196:199], a[28:31]
  s_cmp_ge_u32 s49, 16
  s_cselect_b32 s40, s12, s8
  s_cselect_b32 s41, s13, s9
  s_cselect_b32 s36, s20, s16
  s_cselect_b32 s37, s21, s17
  s_lshl_b32 s55, s49, 2
  s_add_u32 s55, s55, s47
  s_and_b32 s55, s55, 63
  s_mul_i32 s58, s55, 24576
  s_lshl_b32 s51, s55, 7
  s_add_u32 s49, s49, 1
  buffer_load_dwordx4 v[96:99], v212, s[40:43], s58 offen offset:0 nt
  buffer_load_dwordx4 v[100:103], v212, s[40:43], s58 offen offset:384 nt
  buffer_load_dwordx4 v[104:107], v212, s[40:43], s58 offen offset:768 nt
  buffer_load_dwordx4 v[108:111], v212, s[40:43], s58 offen offset:1152 nt
  buffer_load_dwordx4 v[112:115], v212, s[40:43], s58 offen offset:1536 nt
  buffer_load_dwordx4 v[116:119], v212, s[40:43], s58 offen offset:1920 nt
  buffer_load_dwordx4 v[120:123], v212, s[40:43], s58 offen offset:2304 nt
  buffer_load_dwordx4 v[124:127], v212, s[40:43], s58 offen offset:2688 nt
  buffer_load_dwordx4 a[104:107], v215, s[36:39], s51 offen
  s_waitcnt vmcnt(42)
  v_perm_b32 v192, v132, v128, s52
  v_perm_b32 v193, v140, v136, s52
  v_perm_b32 v194, v148, v144, s52
  v_perm_b32 v195, v156, v152, s52
  v_perm_b32 v196, v132, v128, s53
  v_perm_b32 v197, v140, v136, s53
  v_perm_b32 v198, v148, v144, s53
  v_perm_b32 v199, v156, v152, s53
  v_mfma_f32_16x16x32_bf16 a[32:35], a[108:111], v[192:195], a[32:35]
  v_perm_b32 v200, v133, v129, s52
  v_perm_b32 v201, v141, v137, s52
  v_perm_b32 v202, v149, v145, s52
  v_perm_b32 v203, v157, v153, s52
  v_mfma_f32_16x16x32_bf16 a[36:39], a[108:111], v[196:199], a[36:39]
  v_perm_b32 v192, v133, v129, s53
  v_perm_b32 v193, v141, v137, s53
  v_perm_b32 v194, v149, v145, s53
  v_perm_b32 v195, v157, v153, s53
  v_mfma_f32_16x16x32_bf16 a[40:43], a[108:111], v[200:203], a[40:43]
  v_perm_b32 v196, v134, v130, s52
  v_perm_b32 v197, v142, v138, s52
  v_perm_b32 v198, v150, v146, s52
  v_perm_b32 v199, v158, v154, s52
  v_mfma_f32_16x16x32_bf16 a[44:47], a[108:111], v[192:195], a[44:47]
  v_perm_b32 v200, v134, v130, s53
  v_perm_b32 v201, v142, v138, s53
  v_perm_b32 v202, v150, v146, s53
  v_perm_b32 v203, v158, v154, s53
  v_mfma_f32_16x16x32_bf16 a[48:51], a[108:111], v[196:199], a[48:51]
  v_perm_b32 v192, v135, v131, s52
  v_perm_b32 v193, v143, v139, s52
  v_perm_b32 v194, v151, v147, s52
  v_perm_b32 v195, v159, v155, s52
  v_mfma_f32_16x16x32_bf16 a[52:55], a[108:111], v[200:203], a[52:55]
  v_perm_b32 v196, v135, v131, s53
  v_perm_b32 v197, v143, v139, s53
  v_perm_b32 v198, v151, v147, s53
  v_perm_b32 v199, v159, v155, s53
  v_mfma_f32_16x16x32_bf16 a[56:59], a[108:111], v[192:195], a[56:59]
  s_nop 1
  v_mfma_f32_16x16x32_bf16 a[60:63], a[108:111], v[196:199], a[60:63]
  buffer_load_dwordx4 v[128:131], v213, s[40:43], s58 offen offset:0 nt
  buffer_load_dwordx4 v[132:135], v213, s[40:43], s58 offen offset:384 nt
  buffer_load_dwordx4 v[136:139], v213, s[40:43], s58 offen offset:768 nt
  buffer_load_dwordx4 v[140:143], v213, s[40:43], s58 offen offset:1152 nt
  buffer_load_dwordx4 v[144:147], v213, s[40:43], s58 offen offset:1536 nt
  buffer_load_dwordx4 v[148:151], v213, s[40:43], s58 offen offset:1920 nt
  buffer_load_dwordx4 v[152:155], v213, s[40:43], s58 offen offset:2304 nt
  buffer_load_dwordx4 v[156:159], v213, s[40:43], s58 offen offset:2688 nt
  s_waitcnt vmcnt(42)
  v_perm_b32 v192, v164, v160, s52
  v_perm_b32 v193, v172, v168, s52
  v_perm_b32 v194, v180, v176, s52
  v_perm_b32 v195, v188, v184, s52
  v_perm_b32 v196, v164, v160, s53
  v_perm_b32 v197, v172, v168, s53
  v_perm_b32 v198, v180, v176, s53
  v_perm_b32 v199, v188, v184, s53
  v_mfma_f32_16x16x32_bf16 a[64:67], a[108:111], v[192:195], a[64:67]
  v_perm_b32 v200, v165, v161, s52
  v_perm_b32 v201, v173, v169, s52
  v_perm_b32 v202, v181, v177, s52
  v_perm_b32 v203, v189, v185, s52
  v_mfma_f32_16x16x32_bf16 a[68:71], a[108:111], v[196:199], a[68:71]
  v_perm_b32 v192, v165, v161, s53
  v_perm_b32 v193, v173, v169, s53
  v_perm_b32 v194, v181, v177, s53
  v_perm_b32 v195, v189, v185, s53
  v_mfma_f32_16x16x32_bf16 a[72:75], a[108:111], v[200:203], a[72:75]
  v_perm_b32 v196, v166, v162, s52
  v_perm_b32 v197, v174, v170, s52
  v_perm_b32 v198, v182, v178, s52
  v_perm_b32 v199, v190, v186, s52
  v_mfma_f32_16x16x32_bf16 a[76:79], a[108:111], v[192:195], a[76:79]
  v_perm_b32 v200, v166, v162, s53
  v_perm_b32 v201, v174, v170, s53
  v_perm_b32 v202, v182, v178, s53
  v_perm_b32 v203, v190, v186, s53
  v_mfma_f32_16x16x32_bf16 a[80:83], a[108:111], v[196:199], a[80:83]
  v_perm_b32 v192, v167, v163, s52
  v_perm_b32 v193, v175, v171, s52
  v_perm_b32 v194, v183, v179, s52
  v_perm_b32 v195, v191, v187, s52
  v_mfma_f32_16x16x32_bf16 a[84:87], a[108:111], v[200:203], a[84:87]
  v_perm_b32 v196, v167, v163, s53
  v_perm_b32 v197, v175, v171, s53
  v_perm_b32 v198, v183, v179, s53
  v_perm_b32 v199, v191, v187, s53
  v_mfma_f32_16x16x32_bf16 a[88:91], a[108:111], v[192:195], a[88:91]
  s_nop 1
  v_mfma_f32_16x16x32_bf16 a[92:95], a[108:111], v[196:199], a[92:95]
  buffer_load_dwordx4 v[160:163], v214, s[40:43], s58 offen offset:0 nt
  buffer_load_dwordx4 v[164:167], v214, s[40:43], s58 offen offset:384 nt
  buffer_load_dwordx4 v[168:171], v214, s[40:43], s58 offen offset:768 nt
  buffer_load_dwordx4 v[172:175], v214, s[40:43], s58 offen offset:1152 nt
  buffer_load_dwordx4 v[176:179], v214, s[40:43], s58 offen offset:1536 nt
  buffer_load_dwordx4 v[180:183], v214, s[40:43], s58 offen offset:1920 nt
  buffer_load_dwordx4 v[184:187], v214, s[40:43], s58 offen offset:2304 nt
  buffer_load_dwordx4 v[188:191], v214, s[40:43], s58 offen offset:2688 nt
  s_add_u32 s54, s54, 1
  s_cmp_lt_u32 s54, 4
  s_cbranch_scc1 L_kloop
  s_mov_b32 s66, 9984
  s_mov_b32 s67, 1
  s_call_b64 s[74:75], L_dump
  s_mov_b64 exec, 1
  ds_add_rtn_u32 v225, v221, v223 offset:3200
  s_mov_b64 exec, -1
  s_waitcnt lgkmcnt(0)
  v_readfirstlane_b32 s55, v225
  s_cmp_lg_u32 s55, 3
  s_cbranch_scc1 L_nokfin
  v_lshlrev_b32 v200, 4, v218
  v_add_u32 v200, 9984, v200
  v_and_b32 v201, 1, v218
  v_mul_u32_u24 v201, 1600, v201
  v_lshrrev_b32 v202, 1, v218
  v_lshl_add_u32 v201, v202, 4, v201
  s_mov_b32 s54, 0
  s_mov_b32 exec_lo, -1
  s_mov_b32 exec_hi, 0xffff
L_kf1:
  ds_read_b128 v[224:227], v200 offset:0
  ds_read_b128 v[228:231], v200 offset:6400
  ds_read_b128 v[232:235], v200 offset:12800
  ds_read_b128 v[236:239], v200 offset:19200
  ds_read_b128 v[240:243], v200 offset:25600
  ds_read_b128 v[244:247], v200 offset:32000
  ds_read_b128 v[248:251], v200 offset:38400
  ds_read_b128 v[252:255], v200 offset:44800
  s_waitcnt lgkmcnt(6)
  v_add_f32 v192, v224, v228
  v_add_f32 v193, v225, v229
  v_add_f32 v194, v226, v230
  v_add_f32 v195, v227, v231
  s_waitcnt lgkmcnt(5)
  v_add_f32 v192, v192, v232
  v_add_f32 v193, v193, v233
  v_add_f32 v194, v194, v234
  v_add_f32 v195, v195, v235
  s_waitcnt lgkmcnt(4)
  v_add_f32 v192, v192, v236
  v_add_f32 v193, v193, v237
  v_add_f32 v194, v194, v238
  v_add_f32 v195, v195, v239
  s_waitcnt lgkmcnt(3)
  v_add_f32 v192, v192, v240
  v_add_f32 v193, v193, v241
  v_add_f32 v194, v194, v242
  v_add_f32 v195, v195, v243
  s_waitcnt lgkmcnt(2)
  v_add_f32 v192, v192, v244
  v_add_f32 v193, v193, v245
  v_add_f32 v194, v194, v246
  v_add_f32 v195, v195, v247
  s_waitcnt lgkmcnt(1)
  v_add_f32 v192, v192, v248
  v_add_f32 v193, v193, v249
  v_add_f32 v194, v194, v250
  v_add_f32 v195, v195, v251
  s_waitcnt lgkmcnt(0)
  v_add_f32 v192, v192, v252
  v_add_f32 v193, v193, v253
  v_add_f32 v194, v194, v254
  v_add_f32 v195, v195, v255
  ds_read_b128 v[224:227], v200 offset:800
  ds_read_b128 v[228:231], v200 offset:7200
  ds_read_b128 v[232:235], v200 offset:13600
  ds_read_b128 v[236:239], v200 offset:20000
  ds_read_b128 v[240:243], v200 offset:26400
  ds_read_b128 v[244:247], v200 offset:32800
  ds_read_b128 v[248:251], v200 offset:39200
  ds_read_b128 v[252:255], v200 offset:45600
  s_waitcnt lgkmcnt(6)
  v_add_f32 v196, v224, v228
  v_add_f32 v197, v225, v229
  v_add_f32 v198, v226, v230
  v_add_f32 v199, v227, v231
  s_waitcnt lgkmcnt(5)
  v_add_f32 v196, v196, v232
  v_add_f32 v197, v197, v233
  v_add_f32 v198, v198, v234
  v_add_f32 v199, v199, v235
  s_waitcnt lgkmcnt(4)
  v_add_f32 v196, v196, v236
  v_add_f32 v197, v197, v237
  v_add_f32 v198, v198, v238
  v_add_f32 v199, v199, v239
  s_waitcnt lgkmcnt(3)
  v_add_f32 v196, v196, v240
  v_add_f32 v197, v197, v241
  v_add_f32 v198, v198, v242
  v_add_f32 v199, v199, v243
  s_waitcnt lgkmcnt(2)
  v_add_f32 v196, v196, v244
  v_add_f32 v197, v197, v245
  v_add_f32 v198, v198, v246
  v_add_f32 v199, v199, v247
  s_waitcnt lgkmcnt(1)
  v_add_f32 v196, v196, v248
  v_add_f32 v197, v197, v249
  v_add_f32 v198, v198, v250
  v_add_f32 v199, v199, v251
  s_waitcnt lgkmcnt(0)
  v_add_f32 v196, v196, v252
  v_add_f32 v197, v197, v253
  v_add_f32 v198, v198, v254
  v_add_f32 v199, v199, v255
  v_cvt_pk_bf16_f32 v224, v192, v196
  v_cvt_pk_bf16_f32 v225, v193, v197
  v_cvt_pk_bf16_f32 v226, v194, v198
  v_cvt_pk_bf16_f32 v227, v195, v199
  ds_write_b32 v201, v224 offset:0
  ds_write_b32 v201, v225 offset:400
  ds_write_b32 v201, v226 offset:800
  ds_write_b32 v201, v227 offset:1200
  v_add_u32 v200, 1600, v200
  v_add_u32 v201, 4, v201
  s_add_u32 s54, s54, 1
  s_cmp_lt_u32 s54, 4
  s_cbranch_scc1 L_kf1
  s_mov_b64 exec, -1
  v_and_b32 v200, 7, v220
  v_mul_u32_u24 v200, 400, v200
  v_lshl_add_u32 v200, v219, 4, v200
  v_mul_u32_u24 v201, 384, v220
  v_lshl_add_u32 v201, v219, 4, v201
  s_waitcnt lgkmcnt(0)
  ds_read_b128 v[224:227], v200 offset:0
  ds_read_b128 v[228:231], v201 offset:3840
  ds_read_b128 v[232:235], v200 offset:64
  ds_read_b128 v[236:239], v201 offset:3904
  ds_read_b128 v[240:243], v200 offset:128
  ds_read_b128 v[244:247], v201 offset:3968
  s_waitcnt lgkmcnt(4)
  v_mfma_f32_16x16x32_bf16 v[192:195], v[224:227], v[228:231], 0
  s_waitcnt lgkmcnt(2)
  v_mfma_f32_16x16x32_bf16 v[192:195], v[232:235], v[236:239], v[192:195]
  s_waitcnt lgkmcnt(0)
  v_mfma_f32_16x16x32_bf16 v[192:195], v[240:243], v[244:247], v[192:195]
  ds_read_b128 v[224:227], v200 offset:192
  ds_read_b128 v[228:231], v201 offset:4032
  ds_read_b128 v[232:235], v200 offset:256
  ds_read_b128 v[236:239], v201 offset:4096
  ds_read_b128 v[240:243], v200 offset:320
  ds_read_b128 v[244:247], v201 offset:4160
  s_waitcnt lgkmcnt(4)
  v_mfma_f32_16x16x32_bf16 v[192:195], v[224:227], v[228:231], v[192:195]
  s_waitcnt lgkmcnt(2)
  v_mfma_f32_16x16x32_bf16 v[192:195], v[232:235], v[236:239], v[192:195]
  s_waitcnt lgkmcnt(0)
  v_mfma_f32_16x16x32_bf16 v[192:195], v[240:243], v[244:247], v[192:195]
  s_nop 7
  s_nop 1
  v_cvt_pk_bf16_f32 v224, v192, v193
  v_cvt_pk_bf16_f32 v225, v194, v195
  v_lshlrev_b32 v192, 16, v224
  v_and_b32 v193, 0xffff0000, v224
  v_lshlrev_b32 v194, 16, v225
  v_and_b32 v195, 0xffff0000, v225
  v_mul_f32 v192, 0x3d93cd3a, v192
  v_mul_f32 v193, 0x3d93cd3a, v193
  v_mul_f32 v194, 0x3d93cd3a, v194
  v_mul_f32 v195, 0x3d93cd3a, v195
  v_cvt_pk_bf16_f32 v224, v192, v193
  v_cvt_pk_bf16_f32 v225, v194, v195
  v_lshlrev_b32 v192, 16, v224
  v_and_b32 v193, 0xffff0000, v224
  v_lshlrev_b32 v194, 16, v225
  v_and_b32 v195, 0xffff0000, v225
  v_max_f32 v224, v192, v193
  v_max3_f32 v224, v194, v195, v224
  ds_swizzle_b32 v225, v224 offset:0x401F
  s_waitcnt lgkmcnt(0)
  v_max_f32 v224, v224, v225
  v_sub_f32 v192, v192, v224
  v_sub_f32 v193, v193, v224
  v_sub_f32 v194, v194, v224
  v_sub_f32 v195, v195, v224
  v_mul_f32 v192, 0x3fb8aa3b, v192
  v_mul_f32 v193, 0x3fb8aa3b, v193
  v_mul_f32 v194, 0x3fb8aa3b, v194
  v_mul_f32 v195, 0x3fb8aa3b, v195
  v_exp_f32 v192, v192
  v_exp_f32 v193, v193
  v_exp_f32 v194, v194
  v_exp_f32 v195, v195
  s_nop 0
  v_add_f32 v224, v192, v193
  v_add_f32 v225, v194, v195
  v_add_f32 v224, v224, v225
  ds_swizzle_b32 v225, v224 offset:0x401F
  s_waitcnt lgkmcnt(0)
  v_add_f32 v224, v224, v225
  v_rcp_f32 v224, v224
  s_nop 0
  v_mul_f32 v192, v192, v224
  v_mul_f32 v193, v193, v224
  v_mul_f32 v194, v194, v224
  v_mul_f32 v195, v195, v224
  v_cvt_pk_bf16_f32 v216, v192, v193
  v_cvt_pk_bf16_f32 v217, v194, v195
  s_mov_b32 exec_lo, 0
  v_mov_b32 v216, 0
  v_mov_b32 v217, 0
  s_mov_b64 exec, -1
  v_lshlrev_b32 v224, 3, v218
  ds_write_b64 v224, v[216:217] offset:3328
L_nokfin:
  s_barrier
  s_mov_b32 s54, 0
L_vloop:
  s_barrier
  s_waitcnt vmcnt(41)
  v_perm_b32 v192, v4, v0, s52
  v_perm_b32 v193, v12, v8, s52
  v_perm_b32 v194, v20, v16, s52
  v_perm_b32 v195, v28, v24, s52
  v_perm_b32 v196, v4, v0, s53
  v_perm_b32 v197, v12, v8, s53
  v_perm_b32 v198, v20, v16, s53
  v_perm_b32 v199, v28, v24, s53
  v_mfma_f32_16x16x32_bf16 a[0:3], a[96:99], v[192:195], a[0:3]
  v_perm_b32 v200, v5, v1, s52
  v_perm_b32 v201, v13, v9, s52
  v_perm_b32 v202, v21, v17, s52
  v_perm_b32 v203, v29, v25, s52
  v_mfma_f32_16x16x32_bf16 a[4:7], a[96:99], v[196:199], a[4:7]
  v_perm_b32 v192, v5, v1, s53
  v_perm_b32 v193, v13, v9, s53
  v_perm_b32 v194, v21, v17, s53
  v_perm_b32 v195, v29, v25, s53
  v_mfma_f32_16x16x32_bf16 a[8:11], a[96:99], v[200:203], a[8:11]
  v_perm_b32 v196, v6, v2, s52
  v_perm_b32 v197, v14, v10, s52
  v_perm_b32 v198, v22, v18, s52
  v_perm_b32 v199, v30, v26, s52
  v_mfma_f32_16x16x32_bf16 a[12:15], a[96:99], v[192:195], a[12:15]
  v_perm_b32 v200, v6, v2, s53
  v_perm_b32 v201, v14, v10, s53
  v_perm_b32 v202, v22, v18, s53
  v_perm_b32 v203, v30, v26, s53
  v_mfma_f32_16x16x32_bf16 a[16:19], a[96:99], v[196:199], a[16:19]
  v_perm_b32 v192, v7, v3, s52
  v_perm_b32 v193, v15, v11, s52
  v_perm_b32 v194, v23, v19, s52
  v_perm_b32 v195, v31, v27, s52
  v_mfma_f32_16x16x32_bf16 a[20:23], a[96:99], v[200:203], a[20:23]
  v_perm_b32 v196, v7, v3, s53
  v_perm_b32 v197, v15, v11, s53
  v_perm_b32 v198, v23, v19, s53
  v_perm_b32 v199, v31, v27, s53
  v_mfma_f32_16x16x32_bf16 a[24:27], a[96:99], v[192:195], a[24:27]
  s_nop 1
  v_mfma_f32_16x16x32_bf16 a[28:31], a[96:99], v[196:199], a[28:31]
  s_cmp_ge_u32 s49, 16
  s_cselect_b32 s32, s12, s8
  s_cselect_b32 s33, s13, s9
  s_cselect_b32 s36, s20, s16
  s_cselect_b32 s37, s21, s17
  s_lshl_b32 s55, s49, 2
  s_add_u32 s55, s55, s47
  s_and_b32 s55, s55, 63
  s_mul_i32 s50, s55, 24576
  s_lshl_b32 s51, s55, 7
  s_add_u32 s49, s49, 1
  buffer_load_dwordx4 v[0:3], v212, s[32:35], s50 offen offset:0 nt
  buffer_load_dwordx4 v[4:7], v212, s[32:35], s50 offen offset:384 nt
  buffer_load_dwordx4 v[8:11], v212, s[32:35], s50 offen offset:768 nt
  buffer_load_dwordx4 v[12:15], v212, s[32:35], s50 offen offset:1152 nt
  buffer_load_dwordx4 v[16:19], v212, s[32:35], s50 offen offset:1536 nt
  buffer_load_dwordx4 v[20:23], v212, s[32:35], s50 offen offset:1920 nt
  buffer_load_dwordx4 v[24:27], v212, s[32:35], s50 offen offset:2304 nt
  buffer_load_dwordx4 v[28:31], v212, s[32:35], s50 offen offset:2688 nt
  buffer_load_dwordx4 a[100:103], v215, s[36:39], s51 offen
  s_waitcnt vmcnt(42)
  v_perm_b32 v192, v36, v32, s52
  v_perm_b32 v193, v44, v40, s52
  v_perm_b32 v194, v52, v48, s52
  v_perm_b32 v195, v60, v56, s52
  v_perm_b32 v196, v36, v32, s53
  v_perm_b32 v197, v44, v40, s53
  v_perm_b32 v198, v52, v48, s53
  v_perm_b32 v199, v60, v56, s53
  v_mfma_f32_16x16x32_bf16 a[32:35], a[96:99], v[192:195], a[32:35]
  v_perm_b32 v200, v37, v33, s52
  v_perm_b32 v201, v45, v41, s52
  v_perm_b32 v202, v53, v49, s52
  v_perm_b32 v203, v61, v57, s52
  v_mfma_f32_16x16x32_bf16 a[36:39], a[96:99], v[196:199], a[36:39]
  v_perm_b32 v192, v37, v33, s53
  v_perm_b32 v193, v45, v41, s53
  v_perm_b32 v194, v53, v49, s53
  v_perm_b32 v195, v61, v57, s53
  v_mfma_f32_16x16x32_bf16 a[40:43], a[96:99], v[200:203], a[40:43]
  v_perm_b32 v196, v38, v34, s52
  v_perm_b32 v197, v46, v42, s52
  v_perm_b32 v198, v54, v50, s52
  v_perm_b32 v199, v62, v58, s52
  v_mfma_f32_16x16x32_bf16 a[44:47], a[96:99], v[192:195], a[44:47]
  v_perm_b32 v200, v38, v34, s53
  v_perm_b32 v201, v46, v42, s53
  v_perm_b32 v202, v54, v50, s53
  v_perm_b32 v203, v62, v58, s53
  v_mfma_f32_16x16x32_bf16 a[48:51], a[96:99], v[196:199], a[48:51]
  v_perm_b32 v192, v39, v35, s52
  v_perm_b32 v193, v47, v43, s52
  v_perm_b32 v194, v55, v51, s52
  v_perm_b32 v195, v63, v59, s52
  v_mfma_f32_16x16x32_bf16 a[52:55], a[96:99], v[200:203], a[52:55]
  v_perm_b32 v196, v39, v35, s53
  v_perm_b32 v197, v47, v43, s53
  v_perm_b32 v198, v55, v51, s53
  v_perm_b32 v199, v63, v59, s53
  v_mfma_f32_16x16x32_bf16 a[56:59], a[96:99], v[192:195], a[56:59]
  s_nop 1
  v_mfma_f32_16x16x32_bf16 a[60:63], a[96:99], v[196:199], a[60:63]
  buffer_load_dwordx4 v[32:35], v213, s[32:35], s50 offen offset:0 nt
  buffer_load_dwordx4 v[36:39], v213, s[32:35], s50 offen offset:384 nt
  buffer_load_dwordx4 v[40:43], v213, s[32:35], s50 offen offset:768 nt
  buffer_load_dwordx4 v[44:47], v213, s[32:35], s50 offen offset:1152 nt
  buffer_load_dwordx4 v[48:51], v213, s[32:35], s50 offen offset:1536 nt
  buffer_load_dwordx4 v[52:55], v213, s[32:35], s50 offen offset:1920 nt
  buffer_load_dwordx4 v[56:59], v213, s[32:35], s50 offen offset:2304 nt
  buffer_load_dwordx4 v[60:63], v213, s[32:35], s50 offen offset:2688 nt
  s_waitcnt vmcnt(42)
  v_perm_b32 v192, v68, v64, s52
  v_perm_b32 v193, v76, v72, s52
  v_perm_b32 v194, v84, v80, s52
  v_perm_b32 v195, v92, v88, s52
  v_perm_b32 v196, v68, v64, s53
  v_perm_b32 v197, v76, v72, s53
  v_perm_b32 v198, v84, v80, s53
  v_perm_b32 v199, v92, v88, s53
  v_mfma_f32_16x16x32_bf16 a[64:67], a[96:99], v[192:195], a[64:67]
  v_perm_b32 v200, v69, v65, s52
  v_perm_b32 v201, v77, v73, s52
  v_perm_b32 v202, v85, v81, s52
  v_perm_b32 v203, v93, v89, s52
  v_mfma_f32_16x16x32_bf16 a[68:71], a[96:99], v[196:199], a[68:71]
  v_perm_b32 v192, v69, v65, s53
  v_perm_b32 v193, v77, v73, s53
  v_perm_b32 v194, v85, v81, s53
  v_perm_b32 v195, v93, v89, s53
  v_mfma_f32_16x16x32_bf16 a[72:75], a[96:99], v[200:203], a[72:75]
  v_perm_b32 v196, v70, v66, s52
  v_perm_b32 v197, v78, v74, s52
  v_perm_b32 v198, v86, v82, s52
  v_perm_b32 v199, v94, v90, s52
  v_mfma_f32_16x16x32_bf16 a[76:79], a[96:99], v[192:195], a[76:79]
  v_perm_b32 v200, v70, v66, s53
  v_perm_b32 v201, v78, v74, s53
  v_perm_b32 v202, v86, v82, s53
  v_perm_b32 v203, v94, v90, s53
  v_mfma_f32_16x16x32_bf16 a[80:83], a[96:99], v[196:199], a[80:83]
  v_perm_b32 v192, v71, v67, s52
  v_perm_b32 v193, v79, v75, s52
  v_perm_b32 v194, v87, v83, s52
  v_perm_b32 v195, v95, v91, s52
  v_mfma_f32_16x16x32_bf16 a[84:87], a[96:99], v[200:203], a[84:87]
  v_perm_b32 v196, v71, v67, s53
  v_perm_b32 v197, v79, v75, s53
  v_perm_b32 v198, v87, v83, s53
  v_perm_b32 v199, v95, v91, s53
  v_mfma_f32_16x16x32_bf16 a[88:91], a[96:99], v[192:195], a[88:91]
  s_nop 1
  v_mfma_f32_16x16x32_bf16 a[92:95], a[96:99], v[196:199], a[92:95]
  buffer_load_dwordx4 v[64:67], v214, s[32:35], s50 offen offset:0 nt
  buffer_load_dwordx4 v[68:71], v214, s[32:35], s50 offen offset:384 nt
  buffer_load_dwordx4 v[72:75], v214, s[32:35], s50 offen offset:768 nt
  buffer_load_dwordx4 v[76:79], v214, s[32:35], s50 offen offset:1152 nt
  buffer_load_dwordx4 v[80:83], v214, s[32:35], s50 offen offset:1536 nt
  buffer_load_dwordx4 v[84:87], v214, s[32:35], s50 offen offset:1920 nt
  buffer_load_dwordx4 v[88:91], v214, s[32:35], s50 offen offset:2304 nt
  buffer_load_dwordx4 v[92:95], v214, s[32:35], s50 offen offset:2688 nt
  s_waitcnt vmcnt(41)
  v_perm_b32 v192, v100, v96, s52
  v_perm_b32 v193, v108, v104, s52
  v_perm_b32 v194, v116, v112, s52
  v_perm_b32 v195, v124, v120, s52
  v_perm_b32 v196, v100, v96, s53
  v_perm_b32 v197, v108, v104, s53
  v_perm_b32 v198, v116, v112, s53
  v_perm_b32 v199, v124, v120, s53
  v_mfma_f32_16x16x32_bf16 a[0:3], a[104:107], v[192:195], a[0:3]
  v_perm_b32 v200, v101, v97, s52
  v_perm_b32 v201, v109, v105, s52
  v_perm_b32 v202, v117, v113, s52
  v_perm_b32 v203, v125, v121, s52
  v_mfma_f32_16x16x32_bf16 a[4:7], a[104:107], v[196:199], a[4:7]
  v_perm_b32 v192, v101, v97, s53
  v_perm_b32 v193, v109, v105, s53
  v_perm_b32 v194, v117, v113, s53
  v_perm_b32 v195, v125, v121, s53
  v_mfma_f32_16x16x32_bf16 a[8:11], a[104:107], v[200:203], a[8:11]
  v_perm_b32 v196, v102, v98, s52
  v_perm_b32 v197, v110, v106, s52
  v_perm_b32 v198, v118, v114, s52
  v_perm_b32 v199, v126, v122, s52
  v_mfma_f32_16x16x32_bf16 a[12:15], a[104:107], v[192:195], a[12:15]
  v_perm_b32 v200, v102, v98, s53
  v_perm_b32 v201, v110, v106, s53
  v_perm_b32 v202, v118, v114, s53
  v_perm_b32 v203, v126, v122, s53
  v_mfma_f32_16x16x32_bf16 a[16:19], a[104:107], v[196:199], a[16:19]
  v_perm_b32 v192, v103, v99, s52
  v_perm_b32 v193, v111, v107, s52
  v_perm_b32 v194, v119, v115, s52
  v_perm_b32 v195, v127, v123, s52
  v_mfma_f32_16x16x32_bf16 a[20:23], a[104:107], v[200:203], a[20:23]
  v_perm_b32 v196, v103, v99, s53
  v_perm_b32 v197, v111, v107, s53
  v_perm_b32 v198, v119, v115, s53
  v_perm_b32 v199, v127, v123, s53
  v_mfma_f32_16x16x32_bf16 a[24:27], a[104:107], v[192:195], a[24:27]
  s_nop 1
  v_mfma_f32_16x16x32_bf16 a[28:31], a[104:107], v[196:199], a[28:31]
  s_cmp_ge_u32 s49, 16
  s_cselect_b32 s40, s12, s8
  s_cselect_b32 s41, s13, s9
  s_cselect_b32 s36, s20, s16
  s_cselect_b32 s37, s21, s17
  s_lshl_b32 s55, s49, 2
  s_add_u32 s55, s55, s47
  s_and_b32 s55, s55, 63
  s_mul_i32 s58, s55, 24576
  s_lshl_b32 s51, s55, 7
  s_add_u32 s49, s49, 1
  buffer_load_dwordx4 v[96:99], v212, s[40:43], s58 offen offset:0 nt
  buffer_load_dwordx4 v[100:103], v212, s[40:43], s58 offen offset:384 nt
  buffer_load_dwordx4 v[104:107], v212, s[40:43], s58 offen offset:768 nt
  buffer_load_dwordx4 v[108:111], v212, s[40:43], s58 offen offset:1152 nt
  buffer_load_dwordx4 v[112:115], v212, s[40:43], s58 offen offset:1536 nt
  buffer_load_dwordx4 v[116:119], v212, s[40:43], s58 offen offset:1920 nt
  buffer_load_dwordx4 v[120:123], v212, s[40:43], s58 offen offset:2304 nt
  buffer_load_dwordx4 v[124:127], v212, s[40:43], s58 offen offset:2688 nt
  buffer_load_dwordx4 a[108:111], v215, s[36:39], s51 offen
  s_waitcnt vmcnt(42)
  v_perm_b32 v192, v132, v128, s52
  v_perm_b32 v193, v140, v136, s52
  v_perm_b32 v194, v148, v144, s52
  v_perm_b32 v195, v156, v152, s52
  v_perm_b32 v196, v132, v128, s53
  v_perm_b32 v197, v140, v136, s53
  v_perm_b32 v198, v148, v144, s53
  v_perm_b32 v199, v156, v152, s53
  v_mfma_f32_16x16x32_bf16 a[32:35], a[104:107], v[192:195], a[32:35]
  v_perm_b32 v200, v133, v129, s52
  v_perm_b32 v201, v141, v137, s52
  v_perm_b32 v202, v149, v145, s52
  v_perm_b32 v203, v157, v153, s52
  v_mfma_f32_16x16x32_bf16 a[36:39], a[104:107], v[196:199], a[36:39]
  v_perm_b32 v192, v133, v129, s53
  v_perm_b32 v193, v141, v137, s53
  v_perm_b32 v194, v149, v145, s53
  v_perm_b32 v195, v157, v153, s53
  v_mfma_f32_16x16x32_bf16 a[40:43], a[104:107], v[200:203], a[40:43]
  v_perm_b32 v196, v134, v130, s52
  v_perm_b32 v197, v142, v138, s52
  v_perm_b32 v198, v150, v146, s52
  v_perm_b32 v199, v158, v154, s52
  v_mfma_f32_16x16x32_bf16 a[44:47], a[104:107], v[192:195], a[44:47]
  v_perm_b32 v200, v134, v130, s53
  v_perm_b32 v201, v142, v138, s53
  v_perm_b32 v202, v150, v146, s53
  v_perm_b32 v203, v158, v154, s53
  v_mfma_f32_16x16x32_bf16 a[48:51], a[104:107], v[196:199], a[48:51]
  v_perm_b32 v192, v135, v131, s52
  v_perm_b32 v193, v143, v139, s52
  v_perm_b32 v194, v151, v147, s52
  v_perm_b32 v195, v159, v155, s52
  v_mfma_f32_16x16x32_bf16 a[52:55], a[104:107], v[200:203], a[52:55]
  v_perm_b32 v196, v135, v131, s53
  v_perm_b32 v197, v143, v139, s53
  v_perm_b32 v198, v151, v147, s53
  v_perm_b32 v199, v159, v155, s53
  v_mfma_f32_16x16x32_bf16 a[56:59], a[104:107], v[192:195], a[56:59]
  s_nop 1
  v_mfma_f32_16x16x32_bf16 a[60:63], a[104:107], v[196:199], a[60:63]
  buffer_load_dwordx4 v[128:131], v213, s[40:43], s58 offen offset:0 nt
  buffer_load_dwordx4 v[132:135], v213, s[40:43], s58 offen offset:384 nt
  buffer_load_dwordx4 v[136:139], v213, s[40:43], s58 offen offset:768 nt
  buffer_load_dwordx4 v[140:143], v213, s[40:43], s58 offen offset:1152 nt
  buffer_load_dwordx4 v[144:147], v213, s[40:43], s58 offen offset:1536 nt
  buffer_load_dwordx4 v[148:151], v213, s[40:43], s58 offen offset:1920 nt
  buffer_load_dwordx4 v[152:155], v213, s[40:43], s58 offen offset:2304 nt
  buffer_load_dwordx4 v[156:159], v213, s[40:43], s58 offen offset:2688 nt
  s_waitcnt vmcnt(42)
  v_perm_b32 v192, v164, v160, s52
  v_perm_b32 v193, v172, v168, s52
  v_perm_b32 v194, v180, v176, s52
  v_perm_b32 v195, v188, v184, s52
  v_perm_b32 v196, v164, v160, s53
  v_perm_b32 v197, v172, v168, s53
  v_perm_b32 v198, v180, v176, s53
  v_perm_b32 v199, v188, v184, s53
  v_mfma_f32_16x16x32_bf16 a[64:67], a[104:107], v[192:195], a[64:67]
  v_perm_b32 v200, v165, v161, s52
  v_perm_b32 v201, v173, v169, s52
  v_perm_b32 v202, v181, v177, s52
  v_perm_b32 v203, v189, v185, s52
  v_mfma_f32_16x16x32_bf16 a[68:71], a[104:107], v[196:199], a[68:71]
  v_perm_b32 v192, v165, v161, s53
  v_perm_b32 v193, v173, v169, s53
  v_perm_b32 v194, v181, v177, s53
  v_perm_b32 v195, v189, v185, s53
  v_mfma_f32_16x16x32_bf16 a[72:75], a[104:107], v[200:203], a[72:75]
  v_perm_b32 v196, v166, v162, s52
  v_perm_b32 v197, v174, v170, s52
  v_perm_b32 v198, v182, v178, s52
  v_perm_b32 v199, v190, v186, s52
  v_mfma_f32_16x16x32_bf16 a[76:79], a[104:107], v[192:195], a[76:79]
  v_perm_b32 v200, v166, v162, s53
  v_perm_b32 v201, v174, v170, s53
  v_perm_b32 v202, v182, v178, s53
  v_perm_b32 v203, v190, v186, s53
  v_mfma_f32_16x16x32_bf16 a[80:83], a[104:107], v[196:199], a[80:83]
  v_perm_b32 v192, v167, v163, s52
  v_perm_b32 v193, v175, v171, s52
  v_perm_b32 v194, v183, v179, s52
  v_perm_b32 v195, v191, v187, s52
  v_mfma_f32_16x16x32_bf16 a[84:87], a[104:107], v[200:203], a[84:87]
  v_perm_b32 v196, v167, v163, s53
  v_perm_b32 v197, v175, v171, s53
  v_perm_b32 v198, v183, v179, s53
  v_perm_b32 v199, v191, v187, s53
  v_mfma_f32_16x16x32_bf16 a[88:91], a[104:107], v[192:195], a[88:91]
  s_nop 1
  v_mfma_f32_16x16x32_bf16 a[92:95], a[104:107], v[196:199], a[92:95]
  buffer_load_dwordx4 v[160:163], v214, s[40:43], s58 offen offset:0 nt
  buffer_load_dwordx4 v[164:167], v214, s[40:43], s58 offen offset:384 nt
  buffer_load_dwordx4 v[168:171], v214, s[40:43], s58 offen offset:768 nt
  buffer_load_dwordx4 v[172:175], v214, s[40:43], s58 offen offset:1152 nt
  buffer_load_dwordx4 v[176:179], v214, s[40:43], s58 offen offset:1536 nt
  buffer_load_dwordx4 v[180:183], v214, s[40:43], s58 offen offset:1920 nt
  buffer_load_dwordx4 v[184:187], v214, s[40:43], s58 offen offset:2304 nt
  buffer_load_dwordx4 v[188:191], v214, s[40:43], s58 offen offset:2688 nt
  s_waitcnt vmcnt(41)
  v_perm_b32 v192, v4, v0, s52
  v_perm_b32 v193, v12, v8, s52
  v_perm_b32 v194, v20, v16, s52
  v_perm_b32 v195, v28, v24, s52
  v_perm_b32 v196, v4, v0, s53
  v_perm_b32 v197, v12, v8, s53
  v_perm_b32 v198, v20, v16, s53
  v_perm_b32 v199, v28, v24, s53
  v_mfma_f32_16x16x32_bf16 a[0:3], a[100:103], v[192:195], a[0:3]
  v_perm_b32 v200, v5, v1, s52
  v_perm_b32 v201, v13, v9, s52
  v_perm_b32 v202, v21, v17, s52
  v_perm_b32 v203, v29, v25, s52
  v_mfma_f32_16x16x32_bf16 a[4:7], a[100:103], v[196:199], a[4:7]
  v_perm_b32 v192, v5, v1, s53
  v_perm_b32 v193, v13, v9, s53
  v_perm_b32 v194, v21, v17, s53
  v_perm_b32 v195, v29, v25, s53
  v_mfma_f32_16x16x32_bf16 a[8:11], a[100:103], v[200:203], a[8:11]
  v_perm_b32 v196, v6, v2, s52
  v_perm_b32 v197, v14, v10, s52
  v_perm_b32 v198, v22, v18, s52
  v_perm_b32 v199, v30, v26, s52
  v_mfma_f32_16x16x32_bf16 a[12:15], a[100:103], v[192:195], a[12:15]
  v_perm_b32 v200, v6, v2, s53
  v_perm_b32 v201, v14, v10, s53
  v_perm_b32 v202, v22, v18, s53
  v_perm_b32 v203, v30, v26, s53
  v_mfma_f32_16x16x32_bf16 a[16:19], a[100:103], v[196:199], a[16:19]
  v_perm_b32 v192, v7, v3, s52
  v_perm_b32 v193, v15, v11, s52
  v_perm_b32 v194, v23, v19, s52
  v_perm_b32 v195, v31, v27, s52
  v_mfma_f32_16x16x32_bf16 a[20:23], a[100:103], v[200:203], a[20:23]
  v_perm_b32 v196, v7, v3, s53
  v_perm_b32 v197, v15, v11, s53
  v_perm_b32 v198, v23, v19, s53
  v_perm_b32 v199, v31, v27, s53
  v_mfma_f32_16x16x32_bf16 a[24:27], a[100:103], v[192:195], a[24:27]
  s_nop 1
  v_mfma_f32_16x16x32_bf16 a[28:31], a[100:103], v[196:199], a[28:31]
  s_cmp_ge_u32 s49, 16
  s_cselect_b32 s32, s12, s8
  s_cselect_b32 s33, s13, s9
  s_cselect_b32 s36, s20, s16
  s_cselect_b32 s37, s21, s17
  s_lshl_b32 s55, s49, 2
  s_add_u32 s55, s55, s47
  s_and_b32 s55, s55, 63
  s_mul_i32 s50, s55, 24576
  s_lshl_b32 s51, s55, 7
  s_add_u32 s49, s49, 1
  buffer_load_dwordx4 v[0:3], v212, s[32:35], s50 offen offset:0 nt
  buffer_load_dwordx4 v[4:7], v212, s[32:35], s50 offen offset:384 nt
  buffer_load_dwordx4 v[8:11], v212, s[32:35], s50 offen offset:768 nt
  buffer_load_dwordx4 v[12:15], v212, s[32:35], s50 offen offset:1152 nt
  buffer_load_dwordx4 v[16:19], v212, s[32:35], s50 offen offset:1536 nt
  buffer_load_dwordx4 v[20:23], v212, s[32:35], s50 offen offset:1920 nt
  buffer_load_dwordx4 v[24:27], v212, s[32:35], s50 offen offset:2304 nt
  buffer_load_dwordx4 v[28:31], v212, s[32:35], s50 offen offset:2688 nt
  buffer_load_dwordx4 a[96:99], v215, s[36:39], s51 offen
  s_waitcnt vmcnt(42)
  v_perm_b32 v192, v36, v32, s52
  v_perm_b32 v193, v44, v40, s52
  v_perm_b32 v194, v52, v48, s52
  v_perm_b32 v195, v60, v56, s52
  v_perm_b32 v196, v36, v32, s53
  v_perm_b32 v197, v44, v40, s53
  v_perm_b32 v198, v52, v48, s53
  v_perm_b32 v199, v60, v56, s53
  v_mfma_f32_16x16x32_bf16 a[32:35], a[100:103], v[192:195], a[32:35]
  v_perm_b32 v200, v37, v33, s52
  v_perm_b32 v201, v45, v41, s52
  v_perm_b32 v202, v53, v49, s52
  v_perm_b32 v203, v61, v57, s52
  v_mfma_f32_16x16x32_bf16 a[36:39], a[100:103], v[196:199], a[36:39]
  v_perm_b32 v192, v37, v33, s53
  v_perm_b32 v193, v45, v41, s53
  v_perm_b32 v194, v53, v49, s53
  v_perm_b32 v195, v61, v57, s53
  v_mfma_f32_16x16x32_bf16 a[40:43], a[100:103], v[200:203], a[40:43]
  v_perm_b32 v196, v38, v34, s52
  v_perm_b32 v197, v46, v42, s52
  v_perm_b32 v198, v54, v50, s52
  v_perm_b32 v199, v62, v58, s52
  v_mfma_f32_16x16x32_bf16 a[44:47], a[100:103], v[192:195], a[44:47]
  v_perm_b32 v200, v38, v34, s53
  v_perm_b32 v201, v46, v42, s53
  v_perm_b32 v202, v54, v50, s53
  v_perm_b32 v203, v62, v58, s53
  v_mfma_f32_16x16x32_bf16 a[48:51], a[100:103], v[196:199], a[48:51]
  v_perm_b32 v192, v39, v35, s52
  v_perm_b32 v193, v47, v43, s52
  v_perm_b32 v194, v55, v51, s52
  v_perm_b32 v195, v63, v59, s52
  v_mfma_f32_16x16x32_bf16 a[52:55], a[100:103], v[200:203], a[52:55]
  v_perm_b32 v196, v39, v35, s53
  v_perm_b32 v197, v47, v43, s53
  v_perm_b32 v198, v55, v51, s53
  v_perm_b32 v199, v63, v59, s53
  v_mfma_f32_16x16x32_bf16 a[56:59], a[100:103], v[192:195], a[56:59]
  s_nop 1
  v_mfma_f32_16x16x32_bf16 a[60:63], a[100:103], v[196:199], a[60:63]
  buffer_load_dwordx4 v[32:35], v213, s[32:35], s50 offen offset:0 nt
  buffer_load_dwordx4 v[36:39], v213, s[32:35], s50 offen offset:384 nt
  buffer_load_dwordx4 v[40:43], v213, s[32:35], s50 offen offset:768 nt
  buffer_load_dwordx4 v[44:47], v213, s[32:35], s50 offen offset:1152 nt
  buffer_load_dwordx4 v[48:51], v213, s[32:35], s50 offen offset:1536 nt
  buffer_load_dwordx4 v[52:55], v213, s[32:35], s50 offen offset:1920 nt
  buffer_load_dwordx4 v[56:59], v213, s[32:35], s50 offen offset:2304 nt
  buffer_load_dwordx4 v[60:63], v213, s[32:35], s50 offen offset:2688 nt
  s_waitcnt vmcnt(42)
  v_perm_b32 v192, v68, v64, s52
  v_perm_b32 v193, v76, v72, s52
  v_perm_b32 v194, v84, v80, s52
  v_perm_b32 v195, v92, v88, s52
  v_perm_b32 v196, v68, v64, s53
  v_perm_b32 v197, v76, v72, s53
  v_perm_b32 v198, v84, v80, s53
  v_perm_b32 v199, v92, v88, s53
  v_mfma_f32_16x16x32_bf16 a[64:67], a[100:103], v[192:195], a[64:67]
  v_perm_b32 v200, v69, v65, s52
  v_perm_b32 v201, v77, v73, s52
  v_perm_b32 v202, v85, v81, s52
  v_perm_b32 v203, v93, v89, s52
  v_mfma_f32_16x16x32_bf16 a[68:71], a[100:103], v[196:199], a[68:71]
  v_perm_b32 v192, v69, v65, s53
  v_perm_b32 v193, v77, v73, s53
  v_perm_b32 v194, v85, v81, s53
  v_perm_b32 v195, v93, v89, s53
  v_mfma_f32_16x16x32_bf16 a[72:75], a[100:103], v[200:203], a[72:75]
  v_perm_b32 v196, v70, v66, s52
  v_perm_b32 v197, v78, v74, s52
  v_perm_b32 v198, v86, v82, s52
  v_perm_b32 v199, v94, v90, s52
  v_mfma_f32_16x16x32_bf16 a[76:79], a[100:103], v[192:195], a[76:79]
  v_perm_b32 v200, v70, v66, s53
  v_perm_b32 v201, v78, v74, s53
  v_perm_b32 v202, v86, v82, s53
  v_perm_b32 v203, v94, v90, s53
  v_mfma_f32_16x16x32_bf16 a[80:83], a[100:103], v[196:199], a[80:83]
  v_perm_b32 v192, v71, v67, s52
  v_perm_b32 v193, v79, v75, s52
  v_perm_b32 v194, v87, v83, s52
  v_perm_b32 v195, v95, v91, s52
  v_mfma_f32_16x16x32_bf16 a[84:87], a[100:103], v[200:203], a[84:87]
  v_perm_b32 v196, v71, v67, s53
  v_perm_b32 v197, v79, v75, s53
  v_perm_b32 v198, v87, v83, s53
  v_perm_b32 v199, v95, v91, s53
  v_mfma_f32_16x16x32_bf16 a[88:91], a[100:103], v[192:195], a[88:91]
  s_nop 1
  v_mfma_f32_16x16x32_bf16 a[92:95], a[100:103], v[196:199], a[92:95]
  buffer_load_dwordx4 v[64:67], v214, s[32:35], s50 offen offset:0 nt
  buffer_load_dwordx4 v[68:71], v214, s[32:35], s50 offen offset:384 nt
  buffer_load_dwordx4 v[72:75], v214, s[32:35], s50 offen offset:768 nt
  buffer_load_dwordx4 v[76:79], v214, s[32:35], s50 offen offset:1152 nt
  buffer_load_dwordx4 v[80:83], v214, s[32:35], s50 offen offset:1536 nt
  buffer_load_dwordx4 v[84:87], v214, s[32:35], s50 offen offset:1920 nt
  buffer_load_dwordx4 v[88:91], v214, s[32:35], s50 offen offset:2304 nt
  buffer_load_dwordx4 v[92:95], v214, s[32:35], s50 offen offset:2688 nt
  s_waitcnt vmcnt(41)
  v_perm_b32 v192, v100, v96, s52
  v_perm_b32 v193, v108, v104, s52
  v_perm_b32 v194, v116, v112, s52
  v_perm_b32 v195, v124, v120, s52
  v_perm_b32 v196, v100, v96, s53
  v_perm_b32 v197, v108, v104, s53
  v_perm_b32 v198, v116, v112, s53
  v_perm_b32 v199, v124, v120, s53
  v_mfma_f32_16x16x32_bf16 a[0:3], a[108:111], v[192:195], a[0:3]
  v_perm_b32 v200, v101, v97, s52
  v_perm_b32 v201, v109, v105, s52
  v_perm_b32 v202, v117, v113, s52
  v_perm_b32 v203, v125, v121, s52
  v_mfma_f32_16x16x32_bf16 a[4:7], a[108:111], v[196:199], a[4:7]
  v_perm_b32 v192, v101, v97, s53
  v_perm_b32 v193, v109, v105, s53
  v_perm_b32 v194, v117, v113, s53
  v_perm_b32 v195, v125, v121, s53
  v_mfma_f32_16x16x32_bf16 a[8:11], a[108:111], v[200:203], a[8:11]
  v_perm_b32 v196, v102, v98, s52
  v_perm_b32 v197, v110, v106, s52
  v_perm_b32 v198, v118, v114, s52
  v_perm_b32 v199, v126, v122, s52
  v_mfma_f32_16x16x32_bf16 a[12:15], a[108:111], v[192:195], a[12:15]
  v_perm_b32 v200, v102, v98, s53
  v_perm_b32 v201, v110, v106, s53
  v_perm_b32 v202, v118, v114, s53
  v_perm_b32 v203, v126, v122, s53
  v_mfma_f32_16x16x32_bf16 a[16:19], a[108:111], v[196:199], a[16:19]
  v_perm_b32 v192, v103, v99, s52
  v_perm_b32 v193, v111, v107, s52
  v_perm_b32 v194, v119, v115, s52
  v_perm_b32 v195, v127, v123, s52
  v_mfma_f32_16x16x32_bf16 a[20:23], a[108:111], v[200:203], a[20:23]
  v_perm_b32 v196, v103, v99, s53
  v_perm_b32 v197, v111, v107, s53
  v_perm_b32 v198, v119, v115, s53
  v_perm_b32 v199, v127, v123, s53
  v_mfma_f32_16x16x32_bf16 a[24:27], a[108:111], v[192:195], a[24:27]
  s_nop 1
  v_mfma_f32_16x16x32_bf16 a[28:31], a[108:111], v[196:199], a[28:31]
  s_cmp_ge_u32 s49, 16
  s_cselect_b32 s40, s12, s8
  s_cselect_b32 s41, s13, s9
  s_cselect_b32 s36, s20, s16
  s_cselect_b32 s37, s21, s17
  s_lshl_b32 s55, s49, 2
  s_add_u32 s55, s55, s47
  s_and_b32 s55, s55, 63
  s_mul_i32 s58, s55, 24576
  s_lshl_b32 s51, s55, 7
  s_add_u32 s49, s49, 1
  buffer_load_dwordx4 v[96:99], v212, s[40:43], s58 offen offset:0 nt
  buffer_load_dwordx4 v[100:103], v212, s[40:43], s58 offen offset:384 nt
  buffer_load_dwordx4 v[104:107], v212, s[40:43], s58 offen offset:768 nt
  buffer_load_dwordx4 v[108:111], v212, s[40:43], s58 offen offset:1152 nt
  buffer_load_dwordx4 v[112:115], v212, s[40:43], s58 offen offset:1536 nt
  buffer_load_dwordx4 v[116:119], v212, s[40:43], s58 offen offset:1920 nt
  buffer_load_dwordx4 v[120:123], v212, s[40:43], s58 offen offset:2304 nt
  buffer_load_dwordx4 v[124:127], v212, s[40:43], s58 offen offset:2688 nt
  buffer_load_dwordx4 a[104:107], v215, s[36:39], s51 offen
  s_waitcnt vmcnt(42)
  v_perm_b32 v192, v132, v128, s52
  v_perm_b32 v193, v140, v136, s52
  v_perm_b32 v194, v148, v144, s52
  v_perm_b32 v195, v156, v152, s52
  v_perm_b32 v196, v132, v128, s53
  v_perm_b32 v197, v140, v136, s53
  v_perm_b32 v198, v148, v144, s53
  v_perm_b32 v199, v156, v152, s53
  v_mfma_f32_16x16x32_bf16 a[32:35], a[108:111], v[192:195], a[32:35]
  v_perm_b32 v200, v133, v129, s52
  v_perm_b32 v201, v141, v137, s52
  v_perm_b32 v202, v149, v145, s52
  v_perm_b32 v203, v157, v153, s52
  v_mfma_f32_16x16x32_bf16 a[36:39], a[108:111], v[196:199], a[36:39]
  v_perm_b32 v192, v133, v129, s53
  v_perm_b32 v193, v141, v137, s53
  v_perm_b32 v194, v149, v145, s53
  v_perm_b32 v195, v157, v153, s53
  v_mfma_f32_16x16x32_bf16 a[40:43], a[108:111], v[200:203], a[40:43]
  v_perm_b32 v196, v134, v130, s52
  v_perm_b32 v197, v142, v138, s52
  v_perm_b32 v198, v150, v146, s52
  v_perm_b32 v199, v158, v154, s52
  v_mfma_f32_16x16x32_bf16 a[44:47], a[108:111], v[192:195], a[44:47]
  v_perm_b32 v200, v134, v130, s53
  v_perm_b32 v201, v142, v138, s53
  v_perm_b32 v202, v150, v146, s53
  v_perm_b32 v203, v158, v154, s53
  v_mfma_f32_16x16x32_bf16 a[48:51], a[108:111], v[196:199], a[48:51]
  v_perm_b32 v192, v135, v131, s52
  v_perm_b32 v193, v143, v139, s52
  v_perm_b32 v194, v151, v147, s52
  v_perm_b32 v195, v159, v155, s52
  v_mfma_f32_16x16x32_bf16 a[52:55], a[108:111], v[200:203], a[52:55]
  v_perm_b32 v196, v135, v131, s53
  v_perm_b32 v197, v143, v139, s53
  v_perm_b32 v198, v151, v147, s53
  v_perm_b32 v199, v159, v155, s53
  v_mfma_f32_16x16x32_bf16 a[56:59], a[108:111], v[192:195], a[56:59]
  s_nop 1
  v_mfma_f32_16x16x32_bf16 a[60:63], a[108:111], v[196:199], a[60:63]
  buffer_load_dwordx4 v[128:131], v213, s[40:43], s58 offen offset:0 nt
  buffer_load_dwordx4 v[132:135], v213, s[40:43], s58 offen offset:384 nt
  buffer_load_dwordx4 v[136:139], v213, s[40:43], s58 offen offset:768 nt
  buffer_load_dwordx4 v[140:143], v213, s[40:43], s58 offen offset:1152 nt
  buffer_load_dwordx4 v[144:147], v213, s[40:43], s58 offen offset:1536 nt
  buffer_load_dwordx4 v[148:151], v213, s[40:43], s58 offen offset:1920 nt
  buffer_load_dwordx4 v[152:155], v213, s[40:43], s58 offen offset:2304 nt
  buffer_load_dwordx4 v[156:159], v213, s[40:43], s58 offen offset:2688 nt
  s_waitcnt vmcnt(42)
  v_perm_b32 v192, v164, v160, s52
  v_perm_b32 v193, v172, v168, s52
  v_perm_b32 v194, v180, v176, s52
  v_perm_b32 v195, v188, v184, s52
  v_perm_b32 v196, v164, v160, s53
  v_perm_b32 v197, v172, v168, s53
  v_perm_b32 v198, v180, v176, s53
  v_perm_b32 v199, v188, v184, s53
  v_mfma_f32_16x16x32_bf16 a[64:67], a[108:111], v[192:195], a[64:67]
  v_perm_b32 v200, v165, v161, s52
  v_perm_b32 v201, v173, v169, s52
  v_perm_b32 v202, v181, v177, s52
  v_perm_b32 v203, v189, v185, s52
  v_mfma_f32_16x16x32_bf16 a[68:71], a[108:111], v[196:199], a[68:71]
  v_perm_b32 v192, v165, v161, s53
  v_perm_b32 v193, v173, v169, s53
  v_perm_b32 v194, v181, v177, s53
  v_perm_b32 v195, v189, v185, s53
  v_mfma_f32_16x16x32_bf16 a[72:75], a[108:111], v[200:203], a[72:75]
  v_perm_b32 v196, v166, v162, s52
  v_perm_b32 v197, v174, v170, s52
  v_perm_b32 v198, v182, v178, s52
  v_perm_b32 v199, v190, v186, s52
  v_mfma_f32_16x16x32_bf16 a[76:79], a[108:111], v[192:195], a[76:79]
  v_perm_b32 v200, v166, v162, s53
  v_perm_b32 v201, v174, v170, s53
  v_perm_b32 v202, v182, v178, s53
  v_perm_b32 v203, v190, v186, s53
  v_mfma_f32_16x16x32_bf16 a[80:83], a[108:111], v[196:199], a[80:83]
  v_perm_b32 v192, v167, v163, s52
  v_perm_b32 v193, v175, v171, s52
  v_perm_b32 v194, v183, v179, s52
  v_perm_b32 v195, v191, v187, s52
  v_mfma_f32_16x16x32_bf16 a[84:87], a[108:111], v[200:203], a[84:87]
  v_perm_b32 v196, v167, v163, s53
  v_perm_b32 v197, v175, v171, s53
  v_perm_b32 v198, v183, v179, s53
  v_perm_b32 v199, v191, v187, s53
  v_mfma_f32_16x16x32_bf16 a[88:91], a[108:111], v[192:195], a[88:91]
  s_nop 1
  v_mfma_f32_16x16x32_bf16 a[92:95], a[108:111], v[196:199], a[92:95]
  buffer_load_dwordx4 v[160:163], v214, s[40:43], s58 offen offset:0 nt
  buffer_load_dwordx4 v[164:167], v214, s[40:43], s58 offen offset:384 nt
  buffer_load_dwordx4 v[168:171], v214, s[40:43], s58 offen offset:768 nt
  buffer_load_dwordx4 v[172:175], v214, s[40:43], s58 offen offset:1152 nt
  buffer_load_dwordx4 v[176:179], v214, s[40:43], s58 offen offset:1536 nt
  buffer_load_dwordx4 v[180:183], v214, s[40:43], s58 offen offset:1920 nt
  buffer_load_dwordx4 v[184:187], v214, s[40:43], s58 offen offset:2304 nt
  buffer_load_dwordx4 v[188:191], v214, s[40:43], s58 offen offset:2688 nt
  s_add_u32 s54, s54, 1
  s_cmp_lt_u32 s54, 3
  s_cbranch_scc1 L_vloop
  s_waitcnt vmcnt(41)
  v_perm_b32 v192, v4, v0, s52
  v_perm_b32 v193, v12, v8, s52
  v_perm_b32 v194, v20, v16, s52
  v_perm_b32 v195, v28, v24, s52
  v_perm_b32 v196, v4, v0, s53
  v_perm_b32 v197, v12, v8, s53
  v_perm_b32 v198, v20, v16, s53
  v_perm_b32 v199, v28, v24, s53
  v_mfma_f32_16x16x32_bf16 a[0:3], a[96:99], v[192:195], a[0:3]
  v_perm_b32 v200, v5, v1, s52
  v_perm_b32 v201, v13, v9, s52
  v_perm_b32 v202, v21, v17, s52
  v_perm_b32 v203, v29, v25, s52
  v_mfma_f32_16x16x32_bf16 a[4:7], a[96:99], v[196:199], a[4:7]
  v_perm_b32 v192, v5, v1, s53
  v_perm_b32 v193, v13, v9, s53
  v_perm_b32 v194, v21, v17, s53
  v_perm_b32 v195, v29, v25, s53
  v_mfma_f32_16x16x32_bf16 a[8:11], a[96:99], v[200:203], a[8:11]
  v_perm_b32 v196, v6, v2, s52
  v_perm_b32 v197, v14, v10, s52
  v_perm_b32 v198, v22, v18, s52
  v_perm_b32 v199, v30, v26, s52
  v_mfma_f32_16x16x32_bf16 a[12:15], a[96:99], v[192:195], a[12:15]
  v_perm_b32 v200, v6, v2, s53
  v_perm_b32 v201, v14, v10, s53
  v_perm_b32 v202, v22, v18, s53
  v_perm_b32 v203, v30, v26, s53
  v_mfma_f32_16x16x32_bf16 a[16:19], a[96:99], v[196:199], a[16:19]
  v_perm_b32 v192, v7, v3, s52
  v_perm_b32 v193, v15, v11, s52
  v_perm_b32 v194, v23, v19, s52
  v_perm_b32 v195, v31, v27, s52
  v_mfma_f32_16x16x32_bf16 a[20:23], a[96:99], v[200:203], a[20:23]
  v_perm_b32 v196, v7, v3, s53
  v_perm_b32 v197, v15, v11, s53
  v_perm_b32 v198, v23, v19, s53
  v_perm_b32 v199, v31, v27, s53
  v_mfma_f32_16x16x32_bf16 a[24:27], a[96:99], v[192:195], a[24:27]
  s_nop 1
  v_mfma_f32_16x16x32_bf16 a[28:31], a[96:99], v[196:199], a[28:31]
  s_cmp_ge_u32 s49, 16
  s_cselect_b32 s32, s12, s8
  s_cselect_b32 s33, s13, s9
  s_cselect_b32 s36, s20, s16
  s_cselect_b32 s37, s21, s17
  s_lshl_b32 s55, s49, 2
  s_add_u32 s55, s55, s47
  s_and_b32 s55, s55, 63
  s_mul_i32 s50, s55, 24576
  s_lshl_b32 s51, s55, 7
  s_add_u32 s49, s49, 1
  buffer_load_dwordx4 v[0:3], v212, s[32:35], s50 offen offset:0 nt
  buffer_load_dwordx4 v[4:7], v212, s[32:35], s50 offen offset:384 nt
  buffer_load_dwordx4 v[8:11], v212, s[32:35], s50 offen offset:768 nt
  buffer_load_dwordx4 v[12:15], v212, s[32:35], s50 offen offset:1152 nt
  buffer_load_dwordx4 v[16:19], v212, s[32:35], s50 offen offset:1536 nt
  buffer_load_dwordx4 v[20:23], v212, s[32:35], s50 offen offset:1920 nt
  buffer_load_dwordx4 v[24:27], v212, s[32:35], s50 offen offset:2304 nt
  buffer_load_dwordx4 v[28:31], v212, s[32:35], s50 offen offset:2688 nt
  buffer_load_dwordx4 a[100:103], v215, s[36:39], s51 offen
  s_waitcnt vmcnt(42)
  v_perm_b32 v192, v36, v32, s52
  v_perm_b32 v193, v44, v40, s52
  v_perm_b32 v194, v52, v48, s52
  v_perm_b32 v195, v60, v56, s52
  v_perm_b32 v196, v36, v32, s53
  v_perm_b32 v197, v44, v40, s53
  v_perm_b32 v198, v52, v48, s53
  v_perm_b32 v199, v60, v56, s53
  v_mfma_f32_16x16x32_bf16 a[32:35], a[96:99], v[192:195], a[32:35]
  v_perm_b32 v200, v37, v33, s52
  v_perm_b32 v201, v45, v41, s52
  v_perm_b32 v202, v53, v49, s52
  v_perm_b32 v203, v61, v57, s52
  v_mfma_f32_16x16x32_bf16 a[36:39], a[96:99], v[196:199], a[36:39]
  v_perm_b32 v192, v37, v33, s53
  v_perm_b32 v193, v45, v41, s53
  v_perm_b32 v194, v53, v49, s53
  v_perm_b32 v195, v61, v57, s53
  v_mfma_f32_16x16x32_bf16 a[40:43], a[96:99], v[200:203], a[40:43]
  v_perm_b32 v196, v38, v34, s52
  v_perm_b32 v197, v46, v42, s52
  v_perm_b32 v198, v54, v50, s52
  v_perm_b32 v199, v62, v58, s52
  v_mfma_f32_16x16x32_bf16 a[44:47], a[96:99], v[192:195], a[44:47]
  v_perm_b32 v200, v38, v34, s53
  v_perm_b32 v201, v46, v42, s53
  v_perm_b32 v202, v54, v50, s53
  v_perm_b32 v203, v62, v58, s53
  v_mfma_f32_16x16x32_bf16 a[48:51], a[96:99], v[196:199], a[48:51]
  v_perm_b32 v192, v39, v35, s52
  v_perm_b32 v193, v47, v43, s52
  v_perm_b32 v194, v55, v51, s52
  v_perm_b32 v195, v63, v59, s52
  v_mfma_f32_16x16x32_bf16 a[52:55], a[96:99], v[200:203], a[52:55]
  v_perm_b32 v196, v39, v35, s53
  v_perm_b32 v197, v47, v43, s53
  v_perm_b32 v198, v55, v51, s53
  v_perm_b32 v199, v63, v59, s53
  v_mfma_f32_16x16x32_bf16 a[56:59], a[96:99], v[192:195], a[56:59]
  s_nop 1
  v_mfma_f32_16x16x32_bf16 a[60:63], a[96:99], v[196:199], a[60:63]
  buffer_load_dwordx4 v[32:35], v213, s[32:35], s50 offen offset:0 nt
  buffer_load_dwordx4 v[36:39], v213, s[32:35], s50 offen offset:384 nt
  buffer_load_dwordx4 v[40:43], v213, s[32:35], s50 offen offset:768 nt
  buffer_load_dwordx4 v[44:47], v213, s[32:35], s50 offen offset:1152 nt
  buffer_load_dwordx4 v[48:51], v213, s[32:35], s50 offen offset:1536 nt
  buffer_load_dwordx4 v[52:55], v213, s[32:35], s50 offen offset:1920 nt
  buffer_load_dwordx4 v[56:59], v213, s[32:35], s50 offen offset:2304 nt
  buffer_load_dwordx4 v[60:63], v213, s[32:35], s50 offen offset:2688 nt
  s_waitcnt vmcnt(42)
  v_perm_b32 v192, v68, v64, s52
  v_perm_b32 v193, v76, v72, s52
  v_perm_b32 v194, v84, v80, s52
  v_perm_b32 v195, v92, v88, s52
  v_perm_b32 v196, v68, v64, s53
  v_perm_b32 v197, v76, v72, s53
  v_perm_b32 v198, v84, v80, s53
  v_perm_b32 v199, v92, v88, s53
  v_mfma_f32_16x16x32_bf16 a[64:67], a[96:99], v[192:195], a[64:67]
  v_perm_b32 v200, v69, v65, s52
  v_perm_b32 v201, v77, v73, s52
  v_perm_b32 v202, v85, v81, s52
  v_perm_b32 v203, v93, v89, s52
  v_mfma_f32_16x16x32_bf16 a[68:71], a[96:99], v[196:199], a[68:71]
  v_perm_b32 v192, v69, v65, s53
  v_perm_b32 v193, v77, v73, s53
  v_perm_b32 v194, v85, v81, s53
  v_perm_b32 v195, v93, v89, s53
  v_mfma_f32_16x16x32_bf16 a[72:75], a[96:99], v[200:203], a[72:75]
  v_perm_b32 v196, v70, v66, s52
  v_perm_b32 v197, v78, v74, s52
  v_perm_b32 v198, v86, v82, s52
  v_perm_b32 v199, v94, v90, s52
  v_mfma_f32_16x16x32_bf16 a[76:79], a[96:99], v[192:195], a[76:79]
  v_perm_b32 v200, v70, v66, s53
  v_perm_b32 v201, v78, v74, s53
  v_perm_b32 v202, v86, v82, s53
  v_perm_b32 v203, v94, v90, s53
  v_mfma_f32_16x16x32_bf16 a[80:83], a[96:99], v[196:199], a[80:83]
  v_perm_b32 v192, v71, v67, s52
  v_perm_b32 v193, v79, v75, s52
  v_perm_b32 v194, v87, v83, s52
  v_perm_b32 v195, v95, v91, s52
  v_mfma_f32_16x16x32_bf16 a[84:87], a[96:99], v[200:203], a[84:87]
  v_perm_b32 v196, v71, v67, s53
  v_perm_b32 v197, v79, v75, s53
  v_perm_b32 v198, v87, v83, s53
  v_perm_b32 v199, v95, v91, s53
  v_mfma_f32_16x16x32_bf16 a[88:91], a[96:99], v[192:195], a[88:91]
  s_nop 1
  v_mfma_f32_16x16x32_bf16 a[92:95], a[96:99], v[196:199], a[92:95]
  buffer_load_dwordx4 v[64:67], v214, s[32:35], s50 offen offset:0 nt
  buffer_load_dwordx4 v[68:71], v214, s[32:35], s50 offen offset:384 nt
  buffer_load_dwordx4 v[72:75], v214, s[32:35], s50 offen offset:768 nt
  buffer_load_dwordx4 v[76:79], v214, s[32:35], s50 offen offset:1152 nt
  buffer_load_dwordx4 v[80:83], v214, s[32:35], s50 offen offset:1536 nt
  buffer_load_dwordx4 v[84:87], v214, s[32:35], s50 offen offset:1920 nt
  buffer_load_dwordx4 v[88:91], v214, s[32:35], s50 offen offset:2304 nt
  buffer_load_dwordx4 v[92:95], v214, s[32:35], s50 offen offset:2688 nt
  s_waitcnt vmcnt(41)
  v_perm_b32 v192, v100, v96, s52
  v_perm_b32 v193, v108, v104, s52
  v_perm_b32 v194, v116, v112, s52
  v_perm_b32 v195, v124, v120, s52
  v_perm_b32 v196, v100, v96, s53
  v_perm_b32 v197, v108, v104, s53
  v_perm_b32 v198, v116, v112, s53
  v_perm_b32 v199, v124, v120, s53
  v_mfma_f32_16x16x32_bf16 a[0:3], a[104:107], v[192:195], a[0:3]
  v_perm_b32 v200, v101, v97, s52
  v_perm_b32 v201, v109, v105, s52
  v_perm_b32 v202, v117, v113, s52
  v_perm_b32 v203, v125, v121, s52
  v_mfma_f32_16x16x32_bf16 a[4:7], a[104:107], v[196:199], a[4:7]
  v_perm_b32 v192, v101, v97, s53
  v_perm_b32 v193, v109, v105, s53
  v_perm_b32 v194, v117, v113, s53
  v_perm_b32 v195, v125, v121, s53
  v_mfma_f32_16x16x32_bf16 a[8:11], a[104:107], v[200:203], a[8:11]
  v_perm_b32 v196, v102, v98, s52
  v_perm_b32 v197, v110, v106, s52
  v_perm_b32 v198, v118, v114, s52
  v_perm_b32 v199, v126, v122, s52
  v_mfma_f32_16x16x32_bf16 a[12:15], a[104:107], v[192:195], a[12:15]
  v_perm_b32 v200, v102, v98, s53
  v_perm_b32 v201, v110, v106, s53
  v_perm_b32 v202, v118, v114, s53
  v_perm_b32 v203, v126, v122, s53
  v_mfma_f32_16x16x32_bf16 a[16:19], a[104:107], v[196:199], a[16:19]
  v_perm_b32 v192, v103, v99, s52
  v_perm_b32 v193, v111, v107, s52
  v_perm_b32 v194, v119, v115, s52
  v_perm_b32 v195, v127, v123, s52
  v_mfma_f32_16x16x32_bf16 a[20:23], a[104:107], v[200:203], a[20:23]
  v_perm_b32 v196, v103, v99, s53
  v_perm_b32 v197, v111, v107, s53
  v_perm_b32 v198, v119, v115, s53
  v_perm_b32 v199, v127, v123, s53
  v_mfma_f32_16x16x32_bf16 a[24:27], a[104:107], v[192:195], a[24:27]
  s_nop 1
  v_mfma_f32_16x16x32_bf16 a[28:31], a[104:107], v[196:199], a[28:31]
  s_cmp_ge_u32 s49, 16
  s_cselect_b32 s40, s12, s8
  s_cselect_b32 s41, s13, s9
  s_cselect_b32 s36, s20, s16
  s_cselect_b32 s37, s21, s17
  s_lshl_b32 s55, s49, 2
  s_add_u32 s55, s55, s47
  s_and_b32 s55, s55, 63
  s_mul_i32 s58, s55, 24576
  s_lshl_b32 s51, s55, 7
  s_add_u32 s49, s49, 1
  buffer_load_dwordx4 v[96:99], v212, s[40:43], s58 offen offset:0 nt
  buffer_load_dwordx4 v[100:103], v212, s[40:43], s58 offen offset:384 nt
  buffer_load_dwordx4 v[104:107], v212, s[40:43], s58 offen offset:768 nt
  buffer_load_dwordx4 v[108:111], v212, s[40:43], s58 offen offset:1152 nt
  buffer_load_dwordx4 v[112:115], v212, s[40:43], s58 offen offset:1536 nt
  buffer_load_dwordx4 v[116:119], v212, s[40:43], s58 offen offset:1920 nt
  buffer_load_dwordx4 v[120:123], v212, s[40:43], s58 offen offset:2304 nt
  buffer_load_dwordx4 v[124:127], v212, s[40:43], s58 offen offset:2688 nt
  buffer_load_dwordx4 a[108:111], v215, s[36:39], s51 offen
  s_waitcnt vmcnt(42)
  v_perm_b32 v192, v132, v128, s52
  v_perm_b32 v193, v140, v136, s52
  v_perm_b32 v194, v148, v144, s52
  v_perm_b32 v195, v156, v152, s52
  v_perm_b32 v196, v132, v128, s53
  v_perm_b32 v197, v140, v136, s53
  v_perm_b32 v198, v148, v144, s53
  v_perm_b32 v199, v156, v152, s53
  v_mfma_f32_16x16x32_bf16 a[32:35], a[104:107], v[192:195], a[32:35]
  v_perm_b32 v200, v133, v129, s52
  v_perm_b32 v201, v141, v137, s52
  v_perm_b32 v202, v149, v145, s52
  v_perm_b32 v203, v157, v153, s52
  v_mfma_f32_16x16x32_bf16 a[36:39], a[104:107], v[196:199], a[36:39]
  v_perm_b32 v192, v133, v129, s53
  v_perm_b32 v193, v141, v137, s53
  v_perm_b32 v194, v149, v145, s53
  v_perm_b32 v195, v157, v153, s53
  v_mfma_f32_16x16x32_bf16 a[40:43], a[104:107], v[200:203], a[40:43]
  v_perm_b32 v196, v134, v130, s52
  v_perm_b32 v197, v142, v138, s52
  v_perm_b32 v198, v150, v146, s52
  v_perm_b32 v199, v158, v154, s52
  v_mfma_f32_16x16x32_bf16 a[44:47], a[104:107], v[192:195], a[44:47]
  v_perm_b32 v200, v134, v130, s53
  v_perm_b32 v201, v142, v138, s53
  v_perm_b32 v202, v150, v146, s53
  v_perm_b32 v203, v158, v154, s53
  v_mfma_f32_16x16x32_bf16 a[48:51], a[104:107], v[196:199], a[48:51]
  v_perm_b32 v192, v135, v131, s52
  v_perm_b32 v193, v143, v139, s52
  v_perm_b32 v194, v151, v147, s52
  v_perm_b32 v195, v159, v155, s52
  v_mfma_f32_16x16x32_bf16 a[52:55], a[104:107], v[200:203], a[52:55]
  v_perm_b32 v196, v135, v131, s53
  v_perm_b32 v197, v143, v139, s53
  v_perm_b32 v198, v151, v147, s53
  v_perm_b32 v199, v159, v155, s53
  v_mfma_f32_16x16x32_bf16 a[56:59], a[104:107], v[192:195], a[56:59]
  s_nop 1
  v_mfma_f32_16x16x32_bf16 a[60:63], a[104:107], v[196:199], a[60:63]
  buffer_load_dwordx4 v[128:131], v213, s[40:43], s58 offen offset:0 nt
  buffer_load_dwordx4 v[132:135], v213, s[40:43], s58 offen offset:384 nt
  buffer_load_dwordx4 v[136:139], v213, s[40:43], s58 offen offset:768 nt
  buffer_load_dwordx4 v[140:143], v213, s[40:43], s58 offen offset:1152 nt
  buffer_load_dwordx4 v[144:147], v213, s[40:43], s58 offen offset:1536 nt
  buffer_load_dwordx4 v[148:151], v213, s[40:43], s58 offen offset:1920 nt
  buffer_load_dwordx4 v[152:155], v213, s[40:43], s58 offen offset:2304 nt
  buffer_load_dwordx4 v[156:159], v213, s[40:43], s58 offen offset:2688 nt
  s_waitcnt vmcnt(42)
  v_perm_b32 v192, v164, v160, s52
  v_perm_b32 v193, v172, v168, s52
  v_perm_b32 v194, v180, v176, s52
  v_perm_b32 v195, v188, v184, s52
  v_perm_b32 v196, v164, v160, s53
  v_perm_b32 v197, v172, v168, s53
  v_perm_b32 v198, v180, v176, s53
  v_perm_b32 v199, v188, v184, s53
  v_mfma_f32_16x16x32_bf16 a[64:67], a[104:107], v[192:195], a[64:67]
  v_perm_b32 v200, v165, v161, s52
  v_perm_b32 v201, v173, v169, s52
  v_perm_b32 v202, v181, v177, s52
  v_perm_b32 v203, v189, v185, s52
  v_mfma_f32_16x16x32_bf16 a[68:71], a[104:107], v[196:199], a[68:71]
  v_perm_b32 v192, v165, v161, s53
  v_perm_b32 v193, v173, v169, s53
  v_perm_b32 v194, v181, v177, s53
  v_perm_b32 v195, v189, v185, s53
  v_mfma_f32_16x16x32_bf16 a[72:75], a[104:107], v[200:203], a[72:75]
  v_perm_b32 v196, v166, v162, s52
  v_perm_b32 v197, v174, v170, s52
  v_perm_b32 v198, v182, v178, s52
  v_perm_b32 v199, v190, v186, s52
  v_mfma_f32_16x16x32_bf16 a[76:79], a[104:107], v[192:195], a[76:79]
  v_perm_b32 v200, v166, v162, s53
  v_perm_b32 v201, v174, v170, s53
  v_perm_b32 v202, v182, v178, s53
  v_perm_b32 v203, v190, v186, s53
  v_mfma_f32_16x16x32_bf16 a[80:83], a[104:107], v[196:199], a[80:83]
  v_perm_b32 v192, v167, v163, s52
  v_perm_b32 v193, v175, v171, s52
  v_perm_b32 v194, v183, v179, s52
  v_perm_b32 v195, v191, v187, s52
  v_mfma_f32_16x16x32_bf16 a[84:87], a[104:107], v[200:203], a[84:87]
  v_perm_b32 v196, v167, v163, s53
  v_perm_b32 v197, v175, v171, s53
  v_perm_b32 v198, v183, v179, s53
  v_perm_b32 v199, v191, v187, s53
  v_mfma_f32_16x16x32_bf16 a[88:91], a[104:107], v[192:195], a[88:91]
  s_nop 1
  v_mfma_f32_16x16x32_bf16 a[92:95], a[104:107], v[196:199], a[92:95]
  buffer_load_dwordx4 v[160:163], v214, s[40:43], s58 offen offset:0 nt
  buffer_load_dwordx4 v[164:167], v214, s[40:43], s58 offen offset:384 nt
  buffer_load_dwordx4 v[168:171], v214, s[40:43], s58 offen offset:768 nt
  buffer_load_dwordx4 v[172:175], v214, s[40:43], s58 offen offset:1152 nt
  buffer_load_dwordx4 v[176:179], v214, s[40:43], s58 offen offset:1536 nt
  buffer_load_dwordx4 v[180:183], v214, s[40:43], s58 offen offset:1920 nt
  buffer_load_dwordx4 v[184:187], v214, s[40:43], s58 offen offset:2304 nt
  buffer_load_dwordx4 v[188:191], v214, s[40:43], s58 offen offset:2688 nt
  s_waitcnt vmcnt(41)
  v_perm_b32 v192, v4, v0, s52
  v_perm_b32 v193, v12, v8, s52
  v_perm_b32 v194, v20, v16, s52
  v_perm_b32 v195, v28, v24, s52
  v_perm_b32 v196, v4, v0, s53
  v_perm_b32 v197, v12, v8, s53
  v_perm_b32 v198, v20, v16, s53
  v_perm_b32 v199, v28, v24, s53
  v_mfma_f32_16x16x32_bf16 a[0:3], a[100:103], v[192:195], a[0:3]
  v_perm_b32 v200, v5, v1, s52
  v_perm_b32 v201, v13, v9, s52
  v_perm_b32 v202, v21, v17, s52
  v_perm_b32 v203, v29, v25, s52
  v_mfma_f32_16x16x32_bf16 a[4:7], a[100:103], v[196:199], a[4:7]
  v_perm_b32 v192, v5, v1, s53
  v_perm_b32 v193, v13, v9, s53
  v_perm_b32 v194, v21, v17, s53
  v_perm_b32 v195, v29, v25, s53
  v_mfma_f32_16x16x32_bf16 a[8:11], a[100:103], v[200:203], a[8:11]
  v_perm_b32 v196, v6, v2, s52
  v_perm_b32 v197, v14, v10, s52
  v_perm_b32 v198, v22, v18, s52
  v_perm_b32 v199, v30, v26, s52
  v_mfma_f32_16x16x32_bf16 a[12:15], a[100:103], v[192:195], a[12:15]
  v_perm_b32 v200, v6, v2, s53
  v_perm_b32 v201, v14, v10, s53
  v_perm_b32 v202, v22, v18, s53
  v_perm_b32 v203, v30, v26, s53
  v_mfma_f32_16x16x32_bf16 a[16:19], a[100:103], v[196:199], a[16:19]
  v_perm_b32 v192, v7, v3, s52
  v_perm_b32 v193, v15, v11, s52
  v_perm_b32 v194, v23, v19, s52
  v_perm_b32 v195, v31, v27, s52
  v_mfma_f32_16x16x32_bf16 a[20:23], a[100:103], v[200:203], a[20:23]
  v_perm_b32 v196, v7, v3, s53
  v_perm_b32 v197, v15, v11, s53
  v_perm_b32 v198, v23, v19, s53
  v_perm_b32 v199, v31, v27, s53
  v_mfma_f32_16x16x32_bf16 a[24:27], a[100:103], v[192:195], a[24:27]
  s_nop 1
  v_mfma_f32_16x16x32_bf16 a[28:31], a[100:103], v[196:199], a[28:31]
  s_waitcnt vmcnt(33)
  v_perm_b32 v192, v36, v32, s52
  v_perm_b32 v193, v44, v40, s52
  v_perm_b32 v194, v52, v48, s52
  v_perm_b32 v195, v60, v56, s52
  v_perm_b32 v196, v36, v32, s53
  v_perm_b32 v197, v44, v40, s53
  v_perm_b32 v198, v52, v48, s53
  v_perm_b32 v199, v60, v56, s53
  v_mfma_f32_16x16x32_bf16 a[32:35], a[100:103], v[192:195], a[32:35]
  v_perm_b32 v200, v37, v33, s52
  v_perm_b32 v201, v45, v41, s52
  v_perm_b32 v202, v53, v49, s52
  v_perm_b32 v203, v61, v57, s52
  v_mfma_f32_16x16x32_bf16 a[36:39], a[100:103], v[196:199], a[36:39]
  v_perm_b32 v192, v37, v33, s53
  v_perm_b32 v193, v45, v41, s53
  v_perm_b32 v194, v53, v49, s53
  v_perm_b32 v195, v61, v57, s53
  v_mfma_f32_16x16x32_bf16 a[40:43], a[100:103], v[200:203], a[40:43]
  v_perm_b32 v196, v38, v34, s52
  v_perm_b32 v197, v46, v42, s52
  v_perm_b32 v198, v54, v50, s52
  v_perm_b32 v199, v62, v58, s52
  v_mfma_f32_16x16x32_bf16 a[44:47], a[100:103], v[192:195], a[44:47]
  v_perm_b32 v200, v38, v34, s53
  v_perm_b32 v201, v46, v42, s53
  v_perm_b32 v202, v54, v50, s53
  v_perm_b32 v203, v62, v58, s53
  v_mfma_f32_16x16x32_bf16 a[48:51], a[100:103], v[196:199], a[48:51]
  v_perm_b32 v192, v39, v35, s52
  v_perm_b32 v193, v47, v43, s52
  v_perm_b32 v194, v55, v51, s52
  v_perm_b32 v195, v63, v59, s52
  v_mfma_f32_16x16x32_bf16 a[52:55], a[100:103], v[200:203], a[52:55]
  v_perm_b32 v196, v39, v35, s53
  v_perm_b32 v197, v47, v43, s53
  v_perm_b32 v198, v55, v51, s53
  v_perm_b32 v199, v63, v59, s53
  v_mfma_f32_16x16x32_bf16 a[56:59], a[100:103], v[192:195], a[56:59]
  s_nop 1
  v_mfma_f32_16x16x32_bf16 a[60:63], a[100:103], v[196:199], a[60:63]
  s_waitcnt vmcnt(25)
  v_perm_b32 v192, v68, v64, s52
  v_perm_b32 v193, v76, v72, s52
  v_perm_b32 v194, v84, v80, s52
  v_perm_b32 v195, v92, v88, s52
  v_perm_b32 v196, v68, v64, s53
  v_perm_b32 v197, v76, v72, s53
  v_perm_b32 v198, v84, v80, s53
  v_perm_b32 v199, v92, v88, s53
  v_mfma_f32_16x16x32_bf16 a[64:67], a[100:103], v[192:195], a[64:67]
  v_perm_b32 v200, v69, v65, s52
  v_perm_b32 v201, v77, v73, s52
  v_perm_b32 v202, v85, v81, s52
  v_perm_b32 v203, v93, v89, s52
  v_mfma_f32_16x16x32_bf16 a[68:71], a[100:103], v[196:199], a[68:71]
  v_perm_b32 v192, v69, v65, s53
  v_perm_b32 v193, v77, v73, s53
  v_perm_b32 v194, v85, v81, s53
  v_perm_b32 v195, v93, v89, s53
  v_mfma_f32_16x16x32_bf16 a[72:75], a[100:103], v[200:203], a[72:75]
  v_perm_b32 v196, v70, v66, s52
  v_perm_b32 v197, v78, v74, s52
  v_perm_b32 v198, v86, v82, s52
  v_perm_b32 v199, v94, v90, s52
  v_mfma_f32_16x16x32_bf16 a[76:79], a[100:103], v[192:195], a[76:79]
  v_perm_b32 v200, v70, v66, s53
  v_perm_b32 v201, v78, v74, s53
  v_perm_b32 v202, v86, v82, s53
  v_perm_b32 v203, v94, v90, s53
  v_mfma_f32_16x16x32_bf16 a[80:83], a[100:103], v[196:199], a[80:83]
  v_perm_b32 v192, v71, v67, s52
  v_perm_b32 v193, v79, v75, s52
  v_perm_b32 v194, v87, v83, s52
  v_perm_b32 v195, v95, v91, s52
  v_mfma_f32_16x16x32_bf16 a[84:87], a[100:103], v[200:203], a[84:87]
  v_perm_b32 v196, v71, v67, s53
  v_perm_b32 v197, v79, v75, s53
  v_perm_b32 v198, v87, v83, s53
  v_perm_b32 v199, v95, v91, s53
  v_mfma_f32_16x16x32_bf16 a[88:91], a[100:103], v[192:195], a[88:91]
  s_nop 1
  v_mfma_f32_16x16x32_bf16 a[92:95], a[100:103], v[196:199], a[92:95]
  s_waitcnt vmcnt(16)
  v_perm_b32 v192, v100, v96, s52
  v_perm_b32 v193, v108, v104, s52
  v_perm_b32 v194, v116, v112, s52
  v_perm_b32 v195, v124, v120, s52
  v_perm_b32 v196, v100, v96, s53
  v_perm_b32 v197, v108, v104, s53
  v_perm_b32 v198, v116, v112, s53
  v_perm_b32 v199, v124, v120, s53
  v_mfma_f32_16x16x32_bf16 a[0:3], a[108:111], v[192:195], a[0:3]
  v_perm_b32 v200, v101, v97, s52
  v_perm_b32 v201, v109, v105, s52
  v_perm_b32 v202, v117, v113, s52
  v_perm_b32 v203, v125, v121, s52
  v_mfma_f32_16x16x32_bf16 a[4:7], a[108:111], v[196:199], a[4:7]
  v_perm_b32 v192, v101, v97, s53
  v_perm_b32 v193, v109, v105, s53
  v_perm_b32 v194, v117, v113, s53
  v_perm_b32 v195, v125, v121, s53
  v_mfma_f32_16x16x32_bf16 a[8:11], a[108:111], v[200:203], a[8:11]
  v_perm_b32 v196, v102, v98, s52
  v_perm_b32 v197, v110, v106, s52
  v_perm_b32 v198, v118, v114, s52
  v_perm_b32 v199, v126, v122, s52
  v_mfma_f32_16x16x32_bf16 a[12:15], a[108:111], v[192:195], a[12:15]
  v_perm_b32 v200, v102, v98, s53
  v_perm_b32 v201, v110, v106, s53
  v_perm_b32 v202, v118, v114, s53
  v_perm_b32 v203, v126, v122, s53
  v_mfma_f32_16x16x32_bf16 a[16:19], a[108:111], v[196:199], a[16:19]
  v_perm_b32 v192, v103, v99, s52
  v_perm_b32 v193, v111, v107, s52
  v_perm_b32 v194, v119, v115, s52
  v_perm_b32 v195, v127, v123, s52
  v_mfma_f32_16x16x32_bf16 a[20:23], a[108:111], v[200:203], a[20:23]
  v_perm_b32 v196, v103, v99, s53
  v_perm_b32 v197, v111, v107, s53
  v_perm_b32 v198, v119, v115, s53
  v_perm_b32 v199, v127, v123, s53
  v_mfma_f32_16x16x32_bf16 a[24:27], a[108:111], v[192:195], a[24:27]
  s_nop 1
  v_mfma_f32_16x16x32_bf16 a[28:31], a[108:111], v[196:199], a[28:31]
  s_waitcnt vmcnt(8)
  v_perm_b32 v192, v132, v128, s52
  v_perm_b32 v193, v140, v136, s52
  v_perm_b32 v194, v148, v144, s52
  v_perm_b32 v195, v156, v152, s52
  v_perm_b32 v196, v132, v128, s53
  v_perm_b32 v197, v140, v136, s53
  v_perm_b32 v198, v148, v144, s53
  v_perm_b32 v199, v156, v152, s53
  v_mfma_f32_16x16x32_bf16 a[32:35], a[108:111], v[192:195], a[32:35]
  v_perm_b32 v200, v133, v129, s52
  v_perm_b32 v201, v141, v137, s52
  v_perm_b32 v202, v149, v145, s52
  v_perm_b32 v203, v157, v153, s52
  v_mfma_f32_16x16x32_bf16 a[36:39], a[108:111], v[196:199], a[36:39]
  v_perm_b32 v192, v133, v129, s53
  v_perm_b32 v193, v141, v137, s53
  v_perm_b32 v194, v149, v145, s53
  v_perm_b32 v195, v157, v153, s53
  v_mfma_f32_16x16x32_bf16 a[40:43], a[108:111], v[200:203], a[40:43]
  v_perm_b32 v196, v134, v130, s52
  v_perm_b32 v197, v142, v138, s52
  v_perm_b32 v198, v150, v146, s52
  v_perm_b32 v199, v158, v154, s52
  v_mfma_f32_16x16x32_bf16 a[44:47], a[108:111], v[192:195], a[44:47]
  v_perm_b32 v200, v134, v130, s53
  v_perm_b32 v201, v142, v138, s53
  v_perm_b32 v202, v150, v146, s53
  v_perm_b32 v203, v158, v154, s53
  v_mfma_f32_16x16x32_bf16 a[48:51], a[108:111], v[196:199], a[48:51]
  v_perm_b32 v192, v135, v131, s52
  v_perm_b32 v193, v143, v139, s52
  v_perm_b32 v194, v151, v147, s52
  v_perm_b32 v195, v159, v155, s52
  v_mfma_f32_16x16x32_bf16 a[52:55], a[108:111], v[200:203], a[52:55]
  v_perm_b32 v196, v135, v131, s53
  v_perm_b32 v197, v143, v139, s53
  v_perm_b32 v198, v151, v147, s53
  v_perm_b32 v199, v159, v155, s53
  v_mfma_f32_16x16x32_bf16 a[56:59], a[108:111], v[192:195], a[56:59]
  s_nop 1
  v_mfma_f32_16x16x32_bf16 a[60:63], a[108:111], v[196:199], a[60:63]
  s_waitcnt vmcnt(0)
  v_perm_b32 v192, v164, v160, s52
  v_perm_b32 v193, v172, v168, s52
  v_perm_b32 v194, v180, v176, s52
  v_perm_b32 v195, v188, v184, s52
  v_perm_b32 v196, v164, v160, s53
  v_perm_b32 v197, v172, v168, s53
  v_perm_b32 v198, v180, v176, s53
  v_perm_b32 v199, v188, v184, s53
  v_mfma_f32_16x16x32_bf16 a[64:67], a[108:111], v[192:195], a[64:67]
  v_perm_b32 v200, v165, v161, s52
  v_perm_b32 v201, v173, v169, s52
  v_perm_b32 v202, v181, v177, s52
  v_perm_b32 v203, v189, v185, s52
  v_mfma_f32_16x16x32_bf16 a[68:71], a[108:111], v[196:199], a[68:71]
  v_perm_b32 v192, v165, v161, s53
  v_perm_b32 v193, v173, v169, s53
  v_perm_b32 v194, v181, v177, s53
  v_perm_b32 v195, v189, v185, s53
  v_mfma_f32_16x16x32_bf16 a[72:75], a[108:111], v[200:203], a[72:75]
  v_perm_b32 v196, v166, v162, s52
  v_perm_b32 v197, v174, v170, s52
  v_perm_b32 v198, v182, v178, s52
  v_perm_b32 v199, v190, v186, s52
  v_mfma_f32_16x16x32_bf16 a[76:79], a[108:111], v[192:195], a[76:79]
  v_perm_b32 v200, v166, v162, s53
  v_perm_b32 v201, v174, v170, s53
  v_perm_b32 v202, v182, v178, s53
  v_perm_b32 v203, v190, v186, s53
  v_mfma_f32_16x16x32_bf16 a[80:83], a[108:111], v[196:199], a[80:83]
  v_perm_b32 v192, v167, v163, s52
  v_perm_b32 v193, v175, v171, s52
  v_perm_b32 v194, v183, v179, s52
  v_perm_b32 v195, v191, v187, s52
  v_mfma_f32_16x16x32_bf16 a[84:87], a[108:111], v[200:203], a[84:87]
  v_perm_b32 v196, v167, v163, s53
  v_perm_b32 v197, v175, v171, s53
  v_perm_b32 v198, v183, v179, s53
  v_perm_b32 v199, v191, v187, s53
  v_mfma_f32_16x16x32_bf16 a[88:91], a[108:111], v[192:195], a[88:91]
  s_nop 1
  v_mfma_f32_16x16x32_bf16 a[92:95], a[108:111], v[196:199], a[92:95]
  s_mov_b32 s66, 61184
  s_mov_b32 s67, 0
  s_call_b64 s[74:75], L_dump
  v_and_b32 v224, 7, v220
  v_mul_u32_u24 v224, 800, v224
  v_lshrrev_b32 v225, 3, v220
  v_lshl_add_u32 v224, v225, 5, v224
  v_and_b32 v225, 1, v219
  v_lshl_add_u32 v224, v225, 4, v224
  v_lshrrev_b32 v225, 1, v219
  v_mul_u32_u24 v225, 6400, v225
  v_add_u32 v224, v224, v225
  s_mul_i32 s55, s46, 192
  s_add_u32 s55, s55, 61184
  v_add_u32 v224, s55, v224
  v_mul_u32_u24 v225, 384, v220
  v_lshl_add_u32 v225, v219, 3, v225
  s_mul_i32 s55, s46, 96
  v_add_u32 v225, s55, v225
  v_lshlrev_b32 v236, 3, v218
  s_waitcnt vmcnt(0) lgkmcnt(0)
  s_barrier
  ds_read_b64 v[216:217], v236 offset:3328
  ds_read_b128 v[0:3], v224 offset:0
  ds_read_b128 v[4:7], v224 offset:12800
  ds_read_b128 v[8:11], v224 offset:25600
  ds_read_b128 v[12:15], v224 offset:38400
  ds_read_b128 v[16:19], v224 offset:64
  ds_read_b128 v[20:23], v224 offset:12864
  ds_read_b128 v[24:27], v224 offset:25664
  ds_read_b128 v[28:31], v224 offset:38464
  ds_read_b128 v[32:35], v224 offset:128
  ds_read_b128 v[36:39], v224 offset:12928
  ds_read_b128 v[40:43], v224 offset:25728
  ds_read_b128 v[44:47], v224 offset:38528
  s_waitcnt lgkmcnt(8)
  v_add_f32 v0, v0, v4
  v_add_f32 v8, v8, v12
  v_add_f32 v1, v1, v5
  v_add_f32 v9, v9, v13
  v_add_f32 v2, v2, v6
  v_add_f32 v10, v10, v14
  v_add_f32 v3, v3, v7
  v_add_f32 v11, v11, v15
  v_add_f32 v0, v0, v8
  v_add_f32 v1, v1, v9
  v_add_f32 v2, v2, v10
  v_add_f32 v3, v3, v11
  v_mov_b32 v4, v0
  v_mov_b32 v5, v1
  v_mov_b32 v6, v2
  v_mov_b32 v7, v3
  s_nop 1
  v_permlane32_swap_b32 v0, v4
  v_permlane32_swap_b32 v1, v5
  v_permlane32_swap_b32 v2, v6
  v_permlane32_swap_b32 v3, v7
  s_nop 1
  v_add_f32 v0, v0, v4
  v_add_f32 v1, v1, v5
  v_add_f32 v2, v2, v6
  v_add_f32 v3, v3, v7
  v_cvt_pk_bf16_f32 v8, v0, v1
  v_cvt_pk_bf16_f32 v9, v2, v3
  s_nop 1
  v_mfma_f32_16x16x16_bf16 v[144:147], v[8:9], v[216:217], 0
  s_waitcnt lgkmcnt(4)
  v_add_f32 v16, v16, v20
  v_add_f32 v24, v24, v28
  v_add_f32 v17, v17, v21
  v_add_f32 v25, v25, v29
  v_add_f32 v18, v18, v22
  v_add_f32 v26, v26, v30
  v_add_f32 v19, v19, v23
  v_add_f32 v27, v27, v31
  v_add_f32 v16, v16, v24
  v_add_f32 v17, v17, v25
  v_add_f32 v18, v18, v26
  v_add_f32 v19, v19, v27
  v_mov_b32 v20, v16
  v_mov_b32 v21, v17
  v_mov_b32 v22, v18
  v_mov_b32 v23, v19
  s_nop 1
  v_permlane32_swap_b32 v16, v20
  v_permlane32_swap_b32 v17, v21
  v_permlane32_swap_b32 v18, v22
  v_permlane32_swap_b32 v19, v23
  s_nop 1
  v_add_f32 v16, v16, v20
  v_add_f32 v17, v17, v21
  v_add_f32 v18, v18, v22
  v_add_f32 v19, v19, v23
  v_cvt_pk_bf16_f32 v24, v16, v17
  v_cvt_pk_bf16_f32 v25, v18, v19
  s_nop 1
  v_mfma_f32_16x16x16_bf16 v[148:151], v[24:25], v[216:217], 0
  s_waitcnt lgkmcnt(0)
  v_add_f32 v32, v32, v36
  v_add_f32 v40, v40, v44
  v_add_f32 v33, v33, v37
  v_add_f32 v41, v41, v45
  v_add_f32 v34, v34, v38
  v_add_f32 v42, v42, v46
  v_add_f32 v35, v35, v39
  v_add_f32 v43, v43, v47
  v_add_f32 v32, v32, v40
  v_add_f32 v33, v33, v41
  v_add_f32 v34, v34, v42
  v_add_f32 v35, v35, v43
  v_mov_b32 v36, v32
  v_mov_b32 v37, v33
  v_mov_b32 v38, v34
  v_mov_b32 v39, v35
  s_nop 1
  v_permlane32_swap_b32 v32, v36
  v_permlane32_swap_b32 v33, v37
  v_permlane32_swap_b32 v34, v38
  v_permlane32_swap_b32 v35, v39
  s_nop 1
  v_add_f32 v32, v32, v36
  v_add_f32 v33, v33, v37
  v_add_f32 v34, v34, v38
  v_add_f32 v35, v35, v39
  v_cvt_pk_bf16_f32 v40, v32, v33
  v_cvt_pk_bf16_f32 v41, v34, v35
  s_nop 1
  v_mfma_f32_16x16x16_bf16 v[152:155], v[40:41], v[216:217], 0
  s_nop 7
  v_cvt_pk_bf16_f32 v160, v144, v145
  v_cvt_pk_bf16_f32 v161, v146, v147
  v_cvt_pk_bf16_f32 v162, v148, v149
  v_cvt_pk_bf16_f32 v163, v150, v151
  v_cvt_pk_bf16_f32 v164, v152, v153
  v_cvt_pk_bf16_f32 v165, v154, v155
  buffer_store_dwordx2 v[160:161], v225, s[28:31], 0 offen offset:0
  buffer_store_dwordx2 v[162:163], v225, s[28:31], 0 offen offset:32
  buffer_store_dwordx2 v[164:165], v225, s[28:31], 0 offen offset:64
L_done:
  s_endpgm
L_dump:
  s_nop 7
  v_lshrrev_b32 v200, 1, v219
  v_mul_u32_u24 v200, 6400, v200
  s_mul_i32 s55, s46, 12800
  s_add_u32 s55, s55, s66
  v_add_u32 v200, s55, v200
  v_and_b32 v201, 1, v219
  v_lshl_add_u32 v200, v201, 4, v200
  v_lshl_add_u32 v200, v220, 5, v200
  v_cmp_gt_u32 vcc, 8, v220
  v_mov_b32 v202, -256
  v_mov_b32 v203, 512
  s_nop 0
  v_cndmask_b32 v201, v202, v203, vcc
  v_add_u32 v201, v201, v200
  s_mov_b32 exec_lo, -1
  s_mov_b32 exec_hi, 0
  ds_write_b128 v200, a[0:3] offset:0
  ds_write_b128 v200, a[4:7] offset:800
  ds_write_b128 v200, a[8:11] offset:1600
  ds_write_b128 v200, a[12:15] offset:2400
  ds_write_b128 v200, a[16:19] offset:3200
  ds_write_b128 v200, a[20:23] offset:4000
  ds_write_b128 v200, a[24:27] offset:4800
  ds_write_b128 v200, a[28:31] offset:5600
  s_mov_b32 exec_lo, 0
  s_mov_b32 exec_hi, -1
  ds_write_b128 v200, a[64:67] offset:256
  ds_write_b128 v200, a[68:71] offset:1056
  ds_write_b128 v200, a[72:75] offset:1856
  ds_write_b128 v200, a[76:79] offset:2656
  ds_write_b128 v200, a[80:83] offset:3456
  ds_write_b128 v200, a[84:87] offset:4256
  ds_write_b128 v200, a[88:91] offset:5056
  ds_write_b128 v200, a[92:95] offset:5856
  s_mov_b32 exec_lo, 0x00ff00ff
  s_mov_b32 exec_hi, 0xff00ff00
  ds_write_b128 v201, a[32:35] offset:0
  ds_write_b128 v201, a[36:39] offset:800
  ds_write_b128 v201, a[40:43] offset:1600
  ds_write_b128 v201, a[44:47] offset:2400
  ds_write_b128 v201, a[48:51] offset:3200
  ds_write_b128 v201, a[52:55] offset:4000
  ds_write_b128 v201, a[56:59] offset:4800
  ds_write_b128 v201, a[60:63] offset:5600
  s_mov_b64 exec, -1
  s_waitcnt lgkmcnt(0)
  s_cmp_eq_u32 s67, 0
  s_cbranch_scc1 L_dret
  v_accvgpr_write_b32 a0, 0
  v_accvgpr_write_b32 a1, 0
  v_accvgpr_write_b32 a2, 0
  v_accvgpr_write_b32 a3, 0
  v_accvgpr_write_b32 a4, 0
  v_accvgpr_write_b32 a5, 0
  v_accvgpr_write_b32 a6, 0
  v_accvgpr_write_b32 a7, 0
  v_accvgpr_write_b32 a8, 0
  v_accvgpr_write_b32 a9, 0
  v_accvgpr_write_b32 a10, 0
  v_accvgpr_write_b32 a11, 0
  v_accvgpr_write_b32 a12, 0
  v_accvgpr_write_b32 a13, 0
  v_accvgpr_write_b32 a14, 0
  v_accvgpr_write_b32 a15, 0
  v_accvgpr_write_b32 a16, 0
  v_accvgpr_write_b32 a17, 0
  v_accvgpr_write_b32 a18, 0
  v_accvgpr_write_b32 a19, 0
  v_accvgpr_write_b32 a20, 0
  v_accvgpr_write_b32 a21, 0
  v_accvgpr_write_b32 a22, 0
  v_accvgpr_write_b32 a23, 0
  v_accvgpr_write_b32 a24, 0
  v_accvgpr_write_b32 a25, 0
  v_accvgpr_write_b32 a26, 0
  v_accvgpr_write_b32 a27, 0
  v_accvgpr_write_b32 a28, 0
  v_accvgpr_write_b32 a29, 0
  v_accvgpr_write_b32 a30, 0
  v_accvgpr_write_b32 a31, 0
  v_accvgpr_write_b32 a32, 0
  v_accvgpr_write_b32 a33, 0
  v_accvgpr_write_b32 a34, 0
  v_accvgpr_write_b32 a35, 0
  v_accvgpr_write_b32 a36, 0
  v_accvgpr_write_b32 a37, 0
  v_accvgpr_write_b32 a38, 0
  v_accvgpr_write_b32 a39, 0
  v_accvgpr_write_b32 a40, 0
  v_accvgpr_write_b32 a41, 0
  v_accvgpr_write_b32 a42, 0
  v_accvgpr_write_b32 a43, 0
  v_accvgpr_write_b32 a44, 0
  v_accvgpr_write_b32 a45, 0
  v_accvgpr_write_b32 a46, 0
  v_accvgpr_write_b32 a47, 0
  v_accvgpr_write_b32 a48, 0
  v_accvgpr_write_b32 a49, 0
  v_accvgpr_write_b32 a50, 0
  v_accvgpr_write_b32 a51, 0
  v_accvgpr_write_b32 a52, 0
  v_accvgpr_write_b32 a53, 0
  v_accvgpr_write_b32 a54, 0
  v_accvgpr_write_b32 a55, 0
  v_accvgpr_write_b32 a56, 0
  v_accvgpr_write_b32 a57, 0
  v_accvgpr_write_b32 a58, 0
  v_accvgpr_write_b32 a59, 0
  v_accvgpr_write_b32 a60, 0
  v_accvgpr_write_b32 a61, 0
  v_accvgpr_write_b32 a62, 0
  v_accvgpr_write_b32 a63, 0
  v_accvgpr_write_b32 a64, 0
  v_accvgpr_write_b32 a65, 0
  v_accvgpr_write_b32 a66, 0
  v_accvgpr_write_b32 a67, 0
  v_accvgpr_write_b32 a68, 0
  v_accvgpr_write_b32 a69, 0
  v_accvgpr_write_b32 a70, 0
  v_accvgpr_write_b32 a71, 0
  v_accvgpr_write_b32 a72, 0
  v_accvgpr_write_b32 a73, 0
  v_accvgpr_write_b32 a74, 0
  v_accvgpr_write_b32 a75, 0
  v_accvgpr_write_b32 a76, 0
  v_accvgpr_write_b32 a77, 0
  v_accvgpr_write_b32 a78, 0
  v_accvgpr_write_b32 a79, 0
  v_accvgpr_write_b32 a80, 0
  v_accvgpr_write_b32 a81, 0
  v_accvgpr_write_b32 a82, 0
  v_accvgpr_write_b32 a83, 0
  v_accvgpr_write_b32 a84, 0
  v_accvgpr_write_b32 a85, 0
  v_accvgpr_write_b32 a86, 0
  v_accvgpr_write_b32 a87, 0
  v_accvgpr_write_b32 a88, 0
  v_accvgpr_write_b32 a89, 0
  v_accvgpr_write_b32 a90, 0
  v_accvgpr_write_b32 a91, 0
  v_accvgpr_write_b32 a92, 0
  v_accvgpr_write_b32 a93, 0
  v_accvgpr_write_b32 a94, 0
  v_accvgpr_write_b32 a95, 0
L_dret:
  s_setpc_b64 s[74:75]
.section .rodata,"a"
.p2align 6
.amdhsa_kernel standalone__low_rank_proj_linformer__sampling_kernel
  .amdhsa_next_free_vgpr 368
  .amdhsa_next_free_sgpr 100
  .amdhsa_accum_offset 256
  .amdhsa_group_segment_fixed_size 0
  .amdhsa_kernarg_size 64
  .amdhsa_user_sgpr_count 2
  .amdhsa_user_sgpr_kernarg_segment_ptr 1
  .amdhsa_system_sgpr_workgroup_id_x 1
  .amdhsa_float_denorm_mode_32 3
.end_amdhsa_kernel
```
